```python
import torch

def _softmax(x, axis=-1):
    return torch.softmax(x, dim=axis)
def _gelu(x):
    return torch.nn.functional.gelu(x, approximate="tanh")
def _silu(x):
    return torch.nn.functional.silu(x)
def _sigmoid(x):
    return torch.sigmoid(x)
def _layernorm(x, axis=-1, eps=1e-5):
    m = x.mean(dim=axis, keepdim=True)
    v = x.var(dim=axis, keepdim=True, unbiased=False)
    return (x - m) / torch.sqrt(v + eps)
def _scatter_add(tgt, idx, src, axis=0):
    return tgt.clone().index_add_(axis, idx, src)
def _segment_sum(src, seg, n):
    out = torch.zeros((n,) + src.shape[1:], dtype=src.dtype)
    return out.index_add_(0, seg, src)
def _pad(x, pw):
    flat = tuple(v for pair in reversed(pw) for v in pair)
    return torch.nn.functional.pad(x, flat)

kernel_name = 'gated_mix__ssm_conv_h3__glu_gated_bilinear__prompt'

def setup_inputs():

    _w = (lambda a: (lambda t: t.to(torch.bfloat16) if t.is_floating_point() else t)(torch.as_tensor(a)))
    def _A_setup():
        B, S, D = 1, 2048, 640
        ks = 4
        return {
            "q": _w((lambda *s: torch.randn(*s, dtype=torch.bfloat16) * 0.05)(B, S, D)),
            "k": _w((lambda *s: torch.randn(*s, dtype=torch.bfloat16) * 0.05)(B, S, D)),
            "v": _w((lambda *s: torch.randn(*s, dtype=torch.bfloat16) * 0.05)(B, S, D)),
            "shift_k": _w((lambda *s: torch.randn(*s, dtype=torch.bfloat16) * 0.05)(D, ks) * 0.5),
            "ssm_k": _w((lambda *s: torch.randn(*s, dtype=torch.bfloat16) * 0.1)(D, S) * (1.0 / S ** 0.5)),
            "ssm_D": _w((lambda *s: torch.randn(*s, dtype=torch.bfloat16) * 0.05)(D)),
        }
    _A_in = _A_setup()

    def _B_setup():
        B, S, D, F = 1, 2048, 640, 1536
        return {
            "x": _w((lambda *s: torch.randn(*s, dtype=torch.bfloat16) * 0.05)(B, S, D)),
            "w_gate": _w((lambda *s: torch.randn(*s, dtype=torch.bfloat16) * 0.1)(D, F) * (D ** -0.5)),
            "w_up": _w((lambda *s: torch.randn(*s, dtype=torch.bfloat16) * 0.1)(D, F) * (D ** -0.5)),
            "w_down": _w((lambda *s: torch.randn(*s, dtype=torch.bfloat16) * 0.1)(F, D) * (F ** -0.5)),
        }
    _B_in = _B_setup()

    return {
        "A_q": _A_in["q"],
        "A_k": _A_in["k"],
        "A_v": _A_in["v"],
        "A_shift_k": _A_in["shift_k"],
        "A_ssm_k": _A_in["ssm_k"],
        "A_ssm_D": _A_in["ssm_D"],
        "B_x": _B_in["x"],
        "B_w_gate": _B_in["w_gate"],
        "B_w_up": _B_in["w_up"],
        "B_w_down": _B_in["w_down"],
        "gate_w": _w((lambda *s: torch.randn(*s, dtype=torch.bfloat16) * 0.05)(640) * 16.0),
    }

def reference(A_q, A_k, A_v, A_shift_k, A_ssm_k, A_ssm_D, B_x, B_w_gate, B_w_up, B_w_down, gate_w):
    def _A_ref(q, k, v, shift_k, ssm_k, ssm_D):
        B, S, D = q.shape
        ks = shift_k.shape[-1]
        k_pad = _pad(k, ((0, 0), (ks - 1, 0), (0, 0)))
        k_shift = torch.zeros_like(k)
        for t in range(ks):
            k_shift = k_shift + k_pad[:, t:t + S, :] * shift_k[:, ks - 1 - t][None, None, :]
        kv = k_shift * v
        L = 2 * S
        kv_pad = _pad(kv, ((0, 0), (0, S), (0, 0)))
        kf_pad = _pad(ssm_k, ((0, 0), (0, S)))
        kv_f = (lambda x, axes=(-2,-1): torch.fft.rfft2(x.float(), dim=axes))(kv_pad[:, None, :, :], axes=(1, 2))
        kf_f = (lambda x, axes=(-2,-1): torch.fft.rfft2(x.float(), dim=axes))(kf_pad[:, None, :], axes=(1, 2))
        kf_f = (lambda x, *d: x.permute(*d))(kf_f, 1, 2, 0)
        y_f = kv_f * kf_f[None, :, :, :]
        y = (lambda x, s, axes=(-2,-1): torch.fft.irfft2(x, s=s, dim=axes).to(torch.bfloat16))(y_f, (1, L), axes=(1, 2))[:, 0, :S, :]
        y = y + kv * ssm_D[None, None, :]
        return q * y

    def _B_ref(x, w_gate, w_up, w_down):
        g = torch.einsum("bsd,df->bsf", x, w_gate)
        u = torch.einsum("bsd,df->bsf", x, w_up)
        h = g * u
        return torch.einsum("bsf,fd->bsd", h, w_down)

    x = A_q
    g = _sigmoid((x * gate_w).sum(-1, keepdims=True))
    a = _A_ref(x, A_k, A_v, A_shift_k, A_ssm_k, A_ssm_D)
    b = _B_ref(x, B_w_gate, B_w_up, B_w_down)
    return g * a + (1 - g) * b
```

```asm
; @launch grid=(256,1,1) block=(512,1,1) lds=163840
.amdgcn_target "amdgcn-amd-amdhsa--gfx950"
.text
.globl gated_mix__ssm_conv_h3__glu_gated_bilinear__prompt_kernel
.p2align 8
.type gated_mix__ssm_conv_h3__glu_gated_bilinear__prompt_kernel,@function
gated_mix__ssm_conv_h3__glu_gated_bilinear__prompt_kernel:
    s_cmp_ge_u32 s2, 256
    s_cbranch_scc1 L_end
    s_load_dwordx16 s[32:47], s[0:1], 0
    s_load_dwordx8 s[48:55], s[0:1], 64
    s_load_dwordx2 s[58:59], s[0:1], 104
    v_lshrrev_b32 v1, 6, v0
    v_and_b32 v0, 63, v0
    s_and_b32 s62, s2, 1
    s_lshl_b32 s62, s62, 3
    v_readfirstlane_b32 s60, v1
    s_bfe_u32 s64, s2, 0x30003
    s_add_u32 s62, s62, s64
    s_bfe_u32 s63, s2, 0x20001
    s_mul_i32 s63, s63, 3
    s_lshr_b32 s64, s2, 6
    s_add_u32 s63, s63, s64
    s_cmp_ge_u32 s2, 192
    s_cbranch_scc1 L_aux

    s_cmp_ge_u32 s60, 4
    s_cbranch_scc1 L_loader
    s_and_b32 s64, s2, 7
    s_mul_i32 s64, s64, 24
    s_lshr_b32 s65, s2, 3
    s_add_u32 s64, s64, s65
    s_mul_i32 s76, s64, 21846
    s_lshr_b32 s76, s76, 16
    s_mul_i32 s65, s76, 3
    s_sub_u32 s65, s64, s65
    s_lshl_b32 s77, s65, 2
    s_add_u32 s77, s77, s60
    s_add_u32 s77, s77, 8
    s_mul_i32 s78, s60, 4608
    s_add_u32 s78, s78, 98304
    s_lshr_b32 s79, s2, 3
    s_lshl_b32 s79, s79, 7
    s_and_b32 s65, s2, 7
    s_lshl_b32 s65, s65, 2
    s_add_u32 s79, s79, s65
    s_add_u32 s79, s79, 4096
    v_lshrrev_b32 v1, 2, v0
    v_and_b32 v18, 3, v0
    v_mul_u32_u24 v12, 1280, v1
    v_lshl_add_u32 v12, v18, 4, v12
    s_lshl_b32 s67, s76, 5
    s_sub_u32 s67, s67, 4
    s_mul_i32 s67, s67, 1280
    s_lshl_b32 s73, s77, 6
    s_add_u32 s67, s67, s73
    v_add_u32 v13, s67, v12
    v_add_u32 v14, 20480, v13
    v_add_u32 v15, 40960, v13
    v_and_b32 v16, 31, v0
    s_lshl_b32 s73, s77, 5
    v_add_lshl_u32 v17, v16, s73, 3
    s_waitcnt lgkmcnt(0)
    s_load_dword s61, s[58:59], 0
    s_mov_b32 s20, s34
    s_and_b32 s21, s35, 0xffff
    s_mov_b32 s22, 2621440
    s_mov_b32 s23, 0x20000
    s_mov_b32 s24, s36
    s_and_b32 s25, s37, 0xffff
    s_mov_b32 s26, 2621440
    s_mov_b32 s27, 0x20000
    s_mov_b32 s28, s38
    s_and_b32 s29, s39, 0xffff
    s_mov_b32 s30, 5120
    s_mov_b32 s31, 0x20000
    buffer_load_dwordx2 v[10:11], v17, s[28:31], 0 offen
    s_add_u32 m0, s78, 0
    s_nop 0
    buffer_load_dwordx4 v13, s[20:23], 0 offen nt lds
    s_add_u32 m0, s78, 2304
    s_nop 0
    buffer_load_dwordx4 v13, s[24:27], 0 offen nt lds
    s_add_u32 m0, s78, 1024
    s_nop 0
    buffer_load_dwordx4 v14, s[20:23], 0 offen nt lds
    s_add_u32 m0, s78, 3328
    s_nop 0
    buffer_load_dwordx4 v14, s[24:27], 0 offen nt lds
    s_mov_b64 exec, 0xffff
    s_add_u32 m0, s78, 2048
    s_nop 0
    buffer_load_dwordx4 v15, s[20:23], 0 offen nt lds
    s_add_u32 m0, s78, 4352
    s_nop 0
    buffer_load_dwordx4 v15, s[24:27], 0 offen nt lds
    s_mov_b64 exec, -1
    s_mov_b32 s16, s58
    s_and_b32 s17, s59, 0xffff
    s_mov_b32 s18, 14680064
    s_mov_b32 s19, 0x20000
    v_lshrrev_b32 v25, 2, v0
    v_bfe_u32 v23, v25, 1, 2
    v_xor_b32 v23, v23, v18
    v_lshlrev_b32 v23, 4, v23
    v_lshl_add_u32 v23, v25, 6, v23
    v_add_u32 v23, s78, v23
    v_lshlrev_b32 v24, 12, v25
    v_lshl_add_u32 v24, v18, 4, v24
    v_lshrrev_b32 v25, 5, v0
    v_lshlrev_b32 v20, 10, v25
    v_bfe_u32 v22, v0, 2, 2
    v_lshl_add_u32 v20, v22, 6, v20
    v_bfe_u32 v22, v0, 4, 1
    v_lshl_add_u32 v20, v22, 5, v20
    v_lshl_add_u32 v20, v18, 3, v20
    v_add_u32 v20, s78, v20
    v_sub_u32 v25, 1, v25
    v_lshlrev_b32 v25, 1, v25
    v_bfe_u32 v22, v16, 1, 2
    v_xor_b32 v25, v25, v22
    v_lshlrev_b32 v25, 4, v25
    v_lshl_add_u32 v22, v16, 6, v25
    v_add_u32 v21, s78, v22
    v_xor_b32 v22, 16, v21
    s_sub_u32 s44, 63, s76
    s_lshl_b32 s44, s44, 6
    s_add_u32 s44, s44, 1048576
    s_lshl_b32 s67, s77, 17
    s_add_u32 s44, s44, s67
    s_and_b32 s64, s60, 1
    s_lshr_b32 s65, s60, 1
    v_and_b32 v1, 15, v0
    s_lshl_b32 s66, s64, 6
    v_add_u32 v1, s66, v1
    v_lshrrev_b32 v2, 4, v0
    v_bfe_u32 v3, v1, 1, 3
    v_lshlrev_b32 v1, 7, v1
    v_xor_b32 v4, v2, v3
    v_lshl_add_u32 v58, v4, 4, v1
    v_xor_b32 v4, 4, v4
    v_lshl_add_u32 v59, v4, 4, v1
    v_lshlrev_b32 v5, 11, v2
    v_bfe_u32 v7, v0, 2, 2
    v_lshl_add_u32 v5, v7, 6, v5
    v_and_b32 v8, 3, v0
    v_lshl_add_u32 v5, v8, 3, v5
    s_lshl_b32 s66, s65, 9
    s_add_u32 s66, s66, 16384
    v_add_u32 v5, s66, v5
    v_and_b32 v4, 1, v2
    v_lshl_add_u32 v60, v4, 5, v5
    v_xor_b32 v61, 32, v60
    v_mov_b32 v128, 0
    v_mov_b32 v129, 0
    v_mov_b32 v130, 0
    v_mov_b32 v131, 0
    v_mov_b32 v132, 0
    v_mov_b32 v133, 0
    v_mov_b32 v134, 0
    v_mov_b32 v135, 0
    v_mov_b32 v136, 0
    v_mov_b32 v137, 0
    v_mov_b32 v138, 0
    v_mov_b32 v139, 0
    v_mov_b32 v140, 0
    v_mov_b32 v141, 0
    v_mov_b32 v142, 0
    v_mov_b32 v143, 0
    v_mov_b32 v144, 0
    v_mov_b32 v145, 0
    v_mov_b32 v146, 0
    v_mov_b32 v147, 0
    v_mov_b32 v148, 0
    v_mov_b32 v149, 0
    v_mov_b32 v150, 0
    v_mov_b32 v151, 0
    v_mov_b32 v152, 0
    v_mov_b32 v153, 0
    v_mov_b32 v154, 0
    v_mov_b32 v155, 0
    v_mov_b32 v156, 0
    v_mov_b32 v157, 0
    v_mov_b32 v158, 0
    v_mov_b32 v159, 0
    v_mov_b32 v160, 0
    v_mov_b32 v161, 0
    v_mov_b32 v162, 0
    v_mov_b32 v163, 0
    v_mov_b32 v164, 0
    v_mov_b32 v165, 0
    v_mov_b32 v166, 0
    v_mov_b32 v167, 0
    v_mov_b32 v168, 0
    v_mov_b32 v169, 0
    v_mov_b32 v170, 0
    v_mov_b32 v171, 0
    v_mov_b32 v172, 0
    v_mov_b32 v173, 0
    v_mov_b32 v174, 0
    v_mov_b32 v175, 0
    v_mov_b32 v176, 0
    v_mov_b32 v177, 0
    v_mov_b32 v178, 0
    v_mov_b32 v179, 0
    v_mov_b32 v180, 0
    v_mov_b32 v181, 0
    v_mov_b32 v182, 0
    v_mov_b32 v183, 0
    v_mov_b32 v184, 0
    v_mov_b32 v185, 0
    v_mov_b32 v186, 0
    v_mov_b32 v187, 0
    v_mov_b32 v188, 0
    v_mov_b32 v189, 0
    v_mov_b32 v190, 0
    v_mov_b32 v191, 0
    v_mov_b32 v192, 0
    v_mov_b32 v193, 0
    v_mov_b32 v194, 0
    v_mov_b32 v195, 0
    v_mov_b32 v196, 0
    v_mov_b32 v197, 0
    v_mov_b32 v198, 0
    v_mov_b32 v199, 0
    v_mov_b32 v200, 0
    v_mov_b32 v201, 0
    v_mov_b32 v202, 0
    v_mov_b32 v203, 0
    v_mov_b32 v204, 0
    v_mov_b32 v205, 0
    v_mov_b32 v206, 0
    v_mov_b32 v207, 0
    v_mov_b32 v208, 0
    v_mov_b32 v209, 0
    v_mov_b32 v210, 0
    v_mov_b32 v211, 0
    v_mov_b32 v212, 0
    v_mov_b32 v213, 0
    v_mov_b32 v214, 0
    v_mov_b32 v215, 0
    v_mov_b32 v216, 0
    v_mov_b32 v217, 0
    v_mov_b32 v218, 0
    v_mov_b32 v219, 0
    v_mov_b32 v220, 0
    v_mov_b32 v221, 0
    v_mov_b32 v222, 0
    v_mov_b32 v223, 0
    v_mov_b32 v224, 0
    v_mov_b32 v225, 0
    v_mov_b32 v226, 0
    v_mov_b32 v227, 0
    v_mov_b32 v228, 0
    v_mov_b32 v229, 0
    v_mov_b32 v230, 0
    v_mov_b32 v231, 0
    v_mov_b32 v232, 0
    v_mov_b32 v233, 0
    v_mov_b32 v234, 0
    v_mov_b32 v235, 0
    v_mov_b32 v236, 0
    v_mov_b32 v237, 0
    v_mov_b32 v238, 0
    v_mov_b32 v239, 0
    v_mov_b32 v240, 0
    v_mov_b32 v241, 0
    v_mov_b32 v242, 0
    v_mov_b32 v243, 0
    v_mov_b32 v244, 0
    v_mov_b32 v245, 0
    v_mov_b32 v246, 0
    v_mov_b32 v247, 0
    v_mov_b32 v248, 0
    v_mov_b32 v249, 0
    v_mov_b32 v250, 0
    v_mov_b32 v251, 0
    v_mov_b32 v252, 0
    v_mov_b32 v253, 0
    v_mov_b32 v254, 0
    v_mov_b32 v255, 0
    s_lshl_b32 s66, s62, 1
    s_add_u32 s66, s66, s64
    s_mul_i32 s66, s66, 48
    s_lshl_b32 s67, s63, 2
    s_add_u32 s66, s66, s67
    s_lshl_b32 s67, s65, 1
    s_add_u32 s66, s66, s67
    s_lshl_b32 s66, s66, 12
    s_add_u32 s71, s66, 6291456
    s_add_u32 s72, s71, 4096
    s_mul_i32 s66, s62, 12
    s_add_u32 s66, s66, s63
    s_lshl_b32 s66, s66, 2
    s_add_u32 s66, s66, s60
    s_lshl_b32 s66, s66, 7
    s_add_u32 s73, s66, 131072
    s_mov_b32 s20, s54
    s_and_b32 s21, s55, 0xffff
    s_mov_b32 s22, 2621440
    s_mov_b32 s23, 0x20000
    s_mov_b32 s4, s32
    s_and_b32 s5, s33, 0xffff
    s_mov_b32 s6, 2621440
    s_mov_b32 s7, 0x20000
    s_and_b32 s69, s2, 1
    s_lshl_b32 s69, s69, 4
    s_and_b32 s66, s2, 2
    s_lshl_b32 s66, s66, 2
    s_add_u32 s69, s69, s66
    s_bfe_u32 s66, s2, 0x30003
    s_add_u32 s69, s69, s66
    s_and_b32 s70, s2, 4
    s_lshr_b32 s78, s2, 6
    s_add_u32 s70, s70, s78
    s_lshl_b32 s78, s78, 1
    s_add_u32 s66, s66, s78
    s_mov_b32 s76, 0
    s_mov_b32 s78, 1
    s_mul_i32 s74, s69, 196608
    s_mul_i32 s66, s60, 49152
    s_add_u32 s74, s74, s66
    s_add_u32 s74, s74, 6291456
    s_mul_i32 s75, s70, 245760
    s_mul_i32 s66, s60, 61440
    s_add_u32 s75, s75, s66
    s_add_u32 s75, s75, 12582912
    s_mov_b32 s77, s76

    v_and_b32 v1, 15, v0
    v_lshrrev_b32 v2, 4, v0
    s_lshl_b32 s66, s69, 6
    s_lshl_b32 s67, s60, 4
    s_add_u32 s66, s66, s67
    v_add_u32 v8, s66, v1
    v_mul_u32_u24 v3, 1280, v8
    v_lshl_add_u32 v3, v2, 3, v3
    s_mul_i32 s67, s70, 160
    v_add_u32 v3, s67, v3
    v_lshrrev_b32 v9, 3, v8
    v_lshlrev_b32 v9, 7, v9
    v_and_b32 v8, 7, v8
    v_lshl_add_u32 v9, v8, 2, v9
    v_add_u32 v6, 262144, v9
    v_min_u32 v1, 5, v0
    v_lshlrev_b32 v1, 1, v1
    s_lshr_b32 s66, s69, 1
    s_mul_i32 s66, s66, 12
    s_mul_i32 s67, s60, 3
    s_add_u32 s66, s66, s67
    s_lshl_b32 s66, s66, 2
    s_and_b32 s67, s69, 1
    s_add_u32 s66, s66, s67
    v_add_lshl_u32 v1, v1, s66, 7
    v_add_u32 v7, 131072, v1
    v_lshlrev_b32 v4, 4, v0
    v_add_u32 v5, 4096, v4
    s_waitcnt lgkmcnt(0)
    s_mul_i32 s61, s61, 1664525
    s_add_u32 s61, s61, 1013904223
    s_waitcnt vmcnt(0)
    ds_read_b64_tr_b16 v[64:65], v20 offset:0
    ds_read_b64_tr_b16 v[66:67], v20 offset:256
    ds_read_b64_tr_b16 v[68:69], v20 offset:512
    ds_read_b64_tr_b16 v[70:71], v20 offset:768
    ds_read_b64_tr_b16 v[72:73], v20 offset:1024
    ds_read_b64_tr_b16 v[74:75], v20 offset:2560
    ds_read_b64_tr_b16 v[76:77], v20 offset:2816
    ds_read_b64_tr_b16 v[78:79], v20 offset:3072
    ds_read_b64_tr_b16 v[80:81], v20 offset:3328
    v_alignbit_b32 v10, v10, v10, 16
    v_alignbit_b32 v11, v11, v11, 16
    s_waitcnt lgkmcnt(4)
    v_alignbit_b32 v82, v65, v64, 16
    v_alignbit_b32 v83, v66, v65, 16
    v_alignbit_b32 v84, v67, v66, 16
    v_alignbit_b32 v85, v68, v67, 16
    v_alignbit_b32 v86, v69, v68, 16
    v_alignbit_b32 v87, v70, v69, 16
    v_alignbit_b32 v88, v71, v70, 16
    v_alignbit_b32 v89, v72, v71, 16
    v_alignbit_b32 v90, v73, v72, 16
    v_dot2_f32_bf16 v92, v82, v11, 0
    v_dot2_f32_bf16 v93, v65, v11, 0
    v_dot2_f32_bf16 v94, v83, v11, 0
    v_dot2_f32_bf16 v95, v66, v11, 0
    v_dot2_f32_bf16 v96, v84, v11, 0
    v_dot2_f32_bf16 v97, v67, v11, 0
    v_dot2_f32_bf16 v98, v85, v11, 0
    v_dot2_f32_bf16 v99, v68, v11, 0
    v_dot2_f32_bf16 v100, v86, v11, 0
    v_dot2_f32_bf16 v101, v69, v11, 0
    v_dot2_f32_bf16 v102, v87, v11, 0
    v_dot2_f32_bf16 v103, v70, v11, 0
    v_dot2_f32_bf16 v104, v88, v11, 0
    v_dot2_f32_bf16 v105, v71, v11, 0
    v_dot2_f32_bf16 v106, v89, v11, 0
    v_dot2_f32_bf16 v107, v72, v11, 0
    v_dot2_f32_bf16 v92, v83, v10, v92
    v_dot2_f32_bf16 v93, v66, v10, v93
    v_dot2_f32_bf16 v94, v84, v10, v94
    v_dot2_f32_bf16 v95, v67, v10, v95
    v_dot2_f32_bf16 v96, v85, v10, v96
    v_dot2_f32_bf16 v97, v68, v10, v97
    v_dot2_f32_bf16 v98, v86, v10, v98
    v_dot2_f32_bf16 v99, v69, v10, v99
    v_dot2_f32_bf16 v100, v87, v10, v100
    v_dot2_f32_bf16 v101, v70, v10, v101
    v_dot2_f32_bf16 v102, v88, v10, v102
    v_dot2_f32_bf16 v103, v71, v10, v103
    v_dot2_f32_bf16 v104, v89, v10, v104
    v_dot2_f32_bf16 v105, v72, v10, v105
    v_dot2_f32_bf16 v106, v90, v10, v106
    v_dot2_f32_bf16 v107, v73, v10, v107
    s_waitcnt lgkmcnt(0)
    v_lshlrev_b32 v64, 16, v74
    v_and_b32 v82, 0xffff0000, v74
    v_lshlrev_b32 v65, 16, v75
    v_and_b32 v83, 0xffff0000, v75
    v_lshlrev_b32 v66, 16, v76
    v_and_b32 v84, 0xffff0000, v76
    v_lshlrev_b32 v67, 16, v77
    v_and_b32 v85, 0xffff0000, v77
    v_lshlrev_b32 v68, 16, v78
    v_and_b32 v86, 0xffff0000, v78
    v_lshlrev_b32 v69, 16, v79
    v_and_b32 v87, 0xffff0000, v79
    v_lshlrev_b32 v70, 16, v80
    v_and_b32 v88, 0xffff0000, v80
    v_lshlrev_b32 v71, 16, v81
    v_and_b32 v89, 0xffff0000, v81
    v_mul_f32 v92, v92, v64
    v_mul_f32 v93, v93, v82
    v_mul_f32 v94, v94, v65
    v_mul_f32 v95, v95, v83
    v_mul_f32 v96, v96, v66
    v_mul_f32 v97, v97, v84
    v_mul_f32 v98, v98, v67
    v_mul_f32 v99, v99, v85
    v_mul_f32 v100, v100, v68
    v_mul_f32 v101, v101, v86
    v_mul_f32 v102, v102, v69
    v_mul_f32 v103, v103, v87
    v_mul_f32 v104, v104, v70
    v_mul_f32 v105, v105, v88
    v_mul_f32 v106, v106, v71
    v_mul_f32 v107, v107, v89
    v_cvt_pk_bf16_f32 v64, v107, v106
    v_cvt_pk_bf16_f32 v65, v105, v104
    v_cvt_pk_bf16_f32 v66, v103, v102
    v_cvt_pk_bf16_f32 v67, v101, v100
    v_cvt_pk_bf16_f32 v68, v99, v98
    v_cvt_pk_bf16_f32 v69, v97, v96
    v_cvt_pk_bf16_f32 v70, v95, v94
    v_cvt_pk_bf16_f32 v71, v93, v92
    ds_write_b128 v21, v[64:67]
    ds_write_b128 v22, v[68:71]
    s_waitcnt lgkmcnt(0)
    ds_read_b128 v[72:75], v23
    ds_read_b128 v[76:79], v23 offset:1024
    s_add_u32 s45, s44, 65536
    s_waitcnt lgkmcnt(1)
    buffer_store_dwordx4 v[72:75], v24, s[16:19], s44 offen sc1
    s_waitcnt lgkmcnt(0)
    buffer_store_dwordx4 v[76:79], v24, s[16:19], s45 offen sc1
    s_setprio 3
    s_barrier
    ds_read_b128 v[96:99], v58 offset:0
    ds_read_b64_tr_b16 v[64:65], v60 offset:0
    ds_read_b64_tr_b16 v[66:67], v60 offset:1024
    ds_read_b128 v[100:103], v58 offset:2048
    ds_read_b128 v[104:107], v58 offset:4096
    ds_read_b128 v[108:111], v58 offset:6144
    ds_read_b64_tr_b16 v[80:81], v60 offset:16384
    ds_read_b64_tr_b16 v[82:83], v60 offset:17408
    ds_read_b64_tr_b16 v[68:69], v61 offset:0
    ds_read_b64_tr_b16 v[70:71], v61 offset:1024
    ds_read_b64_tr_b16 v[84:85], v61 offset:16384
    ds_read_b64_tr_b16 v[86:87], v61 offset:17408
    ds_read_b64_tr_b16 v[72:73], v60 offset:256
    ds_read_b64_tr_b16 v[74:75], v60 offset:1280
    ds_read_b64_tr_b16 v[88:89], v60 offset:16640
    ds_read_b64_tr_b16 v[90:91], v60 offset:17664
    ds_read_b64_tr_b16 v[76:77], v61 offset:256
    ds_read_b64_tr_b16 v[78:79], v61 offset:1280
    ds_read_b64_tr_b16 v[92:93], v61 offset:16640
    ds_read_b64_tr_b16 v[94:95], v61 offset:17664
    s_mov_b32 s64, 0
    s_mov_b32 s65, 0
    s_mov_b32 s67, 4294868992
    s_mov_b32 s68, 49152
    .p2align 3
L_g1_loop:
    s_waitcnt lgkmcnt(15)
    v_mfma_f32_16x16x32_bf16 v[128:131], v[64:67], v[96:99], v[128:131]
    ds_read_b128 v[112:115], v59 offset:0
    s_waitcnt lgkmcnt(15)
    v_mfma_f32_16x16x32_bf16 v[132:135], v[64:67], v[100:103], v[132:135]
    ds_read_b128 v[116:119], v59 offset:2048
    s_waitcnt lgkmcnt(15)
    v_mfma_f32_16x16x32_bf16 v[136:139], v[64:67], v[104:107], v[136:139]
    ds_read_b128 v[120:123], v59 offset:4096
    s_waitcnt lgkmcnt(15)
    v_mfma_f32_16x16x32_bf16 v[140:143], v[64:67], v[108:111], v[140:143]
    ds_read_b128 v[124:127], v59 offset:6144
    s_waitcnt lgkmcnt(15)
    v_mfma_f32_16x16x32_bf16 v[192:195], v[80:83], v[96:99], v[192:195]
    ds_read_b64_tr_b16 v[64:65], v60 offset:8192
    v_mfma_f32_16x16x32_bf16 v[196:199], v[80:83], v[100:103], v[196:199]
    ds_read_b64_tr_b16 v[66:67], v60 offset:9216
    v_mfma_f32_16x16x32_bf16 v[200:203], v[80:83], v[104:107], v[200:203]
    v_mfma_f32_16x16x32_bf16 v[204:207], v[80:83], v[108:111], v[204:207]
    ds_read_b64_tr_b16 v[80:81], v60 offset:24576
    s_waitcnt lgkmcnt(15)
    v_mfma_f32_16x16x32_bf16 v[144:147], v[68:71], v[96:99], v[144:147]
    ds_read_b64_tr_b16 v[82:83], v60 offset:25600
    v_mfma_f32_16x16x32_bf16 v[148:151], v[68:71], v[100:103], v[148:151]
    v_mfma_f32_16x16x32_bf16 v[152:155], v[68:71], v[104:107], v[152:155]
    v_mfma_f32_16x16x32_bf16 v[156:159], v[68:71], v[108:111], v[156:159]
    ds_read_b64_tr_b16 v[68:69], v61 offset:8192
    s_waitcnt lgkmcnt(15)
    v_mfma_f32_16x16x32_bf16 v[208:211], v[84:87], v[96:99], v[208:211]
    ds_read_b64_tr_b16 v[70:71], v61 offset:9216
    v_mfma_f32_16x16x32_bf16 v[212:215], v[84:87], v[100:103], v[212:215]
    v_mfma_f32_16x16x32_bf16 v[216:219], v[84:87], v[104:107], v[216:219]
    v_mfma_f32_16x16x32_bf16 v[220:223], v[84:87], v[108:111], v[220:223]
    ds_read_b64_tr_b16 v[84:85], v61 offset:24576
    s_waitcnt lgkmcnt(15)
    v_mfma_f32_16x16x32_bf16 v[160:163], v[72:75], v[96:99], v[160:163]
    ds_read_b64_tr_b16 v[86:87], v61 offset:25600
    v_mfma_f32_16x16x32_bf16 v[164:167], v[72:75], v[100:103], v[164:167]
    v_mfma_f32_16x16x32_bf16 v[168:171], v[72:75], v[104:107], v[168:171]
    v_mfma_f32_16x16x32_bf16 v[172:175], v[72:75], v[108:111], v[172:175]
    ds_read_b64_tr_b16 v[72:73], v60 offset:8448
    s_waitcnt lgkmcnt(15)
    v_mfma_f32_16x16x32_bf16 v[224:227], v[88:91], v[96:99], v[224:227]
    ds_read_b64_tr_b16 v[74:75], v60 offset:9472
    v_mfma_f32_16x16x32_bf16 v[228:231], v[88:91], v[100:103], v[228:231]
    v_mfma_f32_16x16x32_bf16 v[232:235], v[88:91], v[104:107], v[232:235]
    v_mfma_f32_16x16x32_bf16 v[236:239], v[88:91], v[108:111], v[236:239]
    ds_read_b64_tr_b16 v[88:89], v60 offset:24832
    s_waitcnt lgkmcnt(15)
    v_mfma_f32_16x16x32_bf16 v[176:179], v[76:79], v[96:99], v[176:179]
    ds_read_b64_tr_b16 v[90:91], v60 offset:25856
    v_mfma_f32_16x16x32_bf16 v[180:183], v[76:79], v[100:103], v[180:183]
    v_mfma_f32_16x16x32_bf16 v[184:187], v[76:79], v[104:107], v[184:187]
    v_mfma_f32_16x16x32_bf16 v[188:191], v[76:79], v[108:111], v[188:191]
    ds_read_b64_tr_b16 v[76:77], v61 offset:8448
    s_waitcnt lgkmcnt(15)
    v_mfma_f32_16x16x32_bf16 v[240:243], v[92:95], v[96:99], v[240:243]
    ds_read_b64_tr_b16 v[78:79], v61 offset:9472
    v_mfma_f32_16x16x32_bf16 v[244:247], v[92:95], v[100:103], v[244:247]
    v_mfma_f32_16x16x32_bf16 v[248:251], v[92:95], v[104:107], v[248:251]
    v_mfma_f32_16x16x32_bf16 v[252:255], v[92:95], v[108:111], v[252:255]
    ds_read_b64_tr_b16 v[92:93], v61 offset:24832
    ds_read_b64_tr_b16 v[94:95], v61 offset:25856
    s_waitcnt lgkmcnt(14)
    v_mfma_f32_16x16x32_bf16 v[128:131], v[64:67], v[112:115], v[128:131]
    s_cmp_lg_u32 s64, 1
    s_cbranch_scc1 L_g1_nw
    s_waitcnt vmcnt(0)
L_g1_nw:
    v_mfma_f32_16x16x32_bf16 v[132:135], v[64:67], v[116:119], v[132:135]
    s_add_u32 s65, s65, 1
    s_cmp_eq_u32 s65, 3
    s_cselect_b32 s66, s67, s68
    s_cselect_b32 s65, 0, s65
    v_mfma_f32_16x16x32_bf16 v[136:139], v[64:67], v[120:123], v[136:139]
    v_add_u32 v58, s66, v58
    v_mfma_f32_16x16x32_bf16 v[140:143], v[64:67], v[124:127], v[140:143]
    v_add_u32 v59, s66, v59
    s_waitcnt lgkmcnt(12)
    v_mfma_f32_16x16x32_bf16 v[192:195], v[80:83], v[112:115], v[192:195]
    v_add_u32 v60, s66, v60
    v_mfma_f32_16x16x32_bf16 v[196:199], v[80:83], v[116:119], v[196:199]
    v_add_u32 v61, s66, v61
    v_mfma_f32_16x16x32_bf16 v[200:203], v[80:83], v[120:123], v[200:203]
    s_waitcnt lgkmcnt(0)
    s_barrier
    ds_read_b128 v[96:99], v58 offset:0
    v_mfma_f32_16x16x32_bf16 v[204:207], v[80:83], v[124:127], v[204:207]
    ds_read_b64_tr_b16 v[64:65], v60 offset:0
    v_mfma_f32_16x16x32_bf16 v[144:147], v[68:71], v[112:115], v[144:147]
    ds_read_b64_tr_b16 v[66:67], v60 offset:1024
    v_mfma_f32_16x16x32_bf16 v[148:151], v[68:71], v[116:119], v[148:151]
    ds_read_b128 v[100:103], v58 offset:2048
    v_mfma_f32_16x16x32_bf16 v[152:155], v[68:71], v[120:123], v[152:155]
    ds_read_b128 v[104:107], v58 offset:4096
    v_mfma_f32_16x16x32_bf16 v[156:159], v[68:71], v[124:127], v[156:159]
    ds_read_b128 v[108:111], v58 offset:6144
    v_mfma_f32_16x16x32_bf16 v[208:211], v[84:87], v[112:115], v[208:211]
    ds_read_b64_tr_b16 v[80:81], v60 offset:16384
    v_mfma_f32_16x16x32_bf16 v[212:215], v[84:87], v[116:119], v[212:215]
    ds_read_b64_tr_b16 v[82:83], v60 offset:17408
    v_mfma_f32_16x16x32_bf16 v[216:219], v[84:87], v[120:123], v[216:219]
    ds_read_b64_tr_b16 v[68:69], v61 offset:0
    v_mfma_f32_16x16x32_bf16 v[220:223], v[84:87], v[124:127], v[220:223]
    ds_read_b64_tr_b16 v[70:71], v61 offset:1024
    v_mfma_f32_16x16x32_bf16 v[160:163], v[72:75], v[112:115], v[160:163]
    ds_read_b64_tr_b16 v[84:85], v61 offset:16384
    v_mfma_f32_16x16x32_bf16 v[164:167], v[72:75], v[116:119], v[164:167]
    ds_read_b64_tr_b16 v[86:87], v61 offset:17408
    v_mfma_f32_16x16x32_bf16 v[168:171], v[72:75], v[120:123], v[168:171]
    v_mfma_f32_16x16x32_bf16 v[172:175], v[72:75], v[124:127], v[172:175]
    ds_read_b64_tr_b16 v[72:73], v60 offset:256
    v_mfma_f32_16x16x32_bf16 v[224:227], v[88:91], v[112:115], v[224:227]
    ds_read_b64_tr_b16 v[74:75], v60 offset:1280
    v_mfma_f32_16x16x32_bf16 v[228:231], v[88:91], v[116:119], v[228:231]
    s_lshl_b32 s66, s60, 4
    s_add_u32 s66, s66, s64
    s_cmp_lg_u32 s66, 1
    s_cbranch_scc1 L_g1_nf
    v_mov_b32 v1, s61
    v_mov_b32 v2, 0
    s_mov_b64 exec, 1
    buffer_store_dword v1, v2, s[16:19], s79 offen sc1
    s_mov_b64 exec, -1
L_g1_nf:
    v_mfma_f32_16x16x32_bf16 v[232:235], v[88:91], v[120:123], v[232:235]
    v_mfma_f32_16x16x32_bf16 v[236:239], v[88:91], v[124:127], v[236:239]
    ds_read_b64_tr_b16 v[88:89], v60 offset:16640
    v_mfma_f32_16x16x32_bf16 v[176:179], v[76:79], v[112:115], v[176:179]
    ds_read_b64_tr_b16 v[90:91], v60 offset:17664
    v_mfma_f32_16x16x32_bf16 v[180:183], v[76:79], v[116:119], v[180:183]
    v_mfma_f32_16x16x32_bf16 v[184:187], v[76:79], v[120:123], v[184:187]
    v_mfma_f32_16x16x32_bf16 v[188:191], v[76:79], v[124:127], v[188:191]
    ds_read_b64_tr_b16 v[76:77], v61 offset:256
    v_mfma_f32_16x16x32_bf16 v[240:243], v[92:95], v[112:115], v[240:243]
    ds_read_b64_tr_b16 v[78:79], v61 offset:1280
    v_mfma_f32_16x16x32_bf16 v[244:247], v[92:95], v[116:119], v[244:247]
    v_mfma_f32_16x16x32_bf16 v[248:251], v[92:95], v[120:123], v[248:251]
    v_mfma_f32_16x16x32_bf16 v[252:255], v[92:95], v[124:127], v[252:255]
    ds_read_b64_tr_b16 v[92:93], v61 offset:16640
    ds_read_b64_tr_b16 v[94:95], v61 offset:17664
    s_add_u32 s64, s64, 1
    s_cmp_lt_u32 s64, 9
    s_cbranch_scc1 L_g1_loop
    s_waitcnt lgkmcnt(15)
    v_mfma_f32_16x16x32_bf16 v[128:131], v[64:67], v[96:99], v[128:131]
    ds_read_b128 v[112:115], v59 offset:0
    s_waitcnt lgkmcnt(15)
    v_mfma_f32_16x16x32_bf16 v[132:135], v[64:67], v[100:103], v[132:135]
    ds_read_b128 v[116:119], v59 offset:2048
    s_waitcnt lgkmcnt(15)
    v_mfma_f32_16x16x32_bf16 v[136:139], v[64:67], v[104:107], v[136:139]
    ds_read_b128 v[120:123], v59 offset:4096
    s_waitcnt lgkmcnt(15)
    v_mfma_f32_16x16x32_bf16 v[140:143], v[64:67], v[108:111], v[140:143]
    ds_read_b128 v[124:127], v59 offset:6144
    s_waitcnt lgkmcnt(15)
    v_mfma_f32_16x16x32_bf16 v[192:195], v[80:83], v[96:99], v[192:195]
    ds_read_b64_tr_b16 v[64:65], v60 offset:8192
    v_mfma_f32_16x16x32_bf16 v[196:199], v[80:83], v[100:103], v[196:199]
    ds_read_b64_tr_b16 v[66:67], v60 offset:9216
    v_mfma_f32_16x16x32_bf16 v[200:203], v[80:83], v[104:107], v[200:203]
    v_mfma_f32_16x16x32_bf16 v[204:207], v[80:83], v[108:111], v[204:207]
    ds_read_b64_tr_b16 v[80:81], v60 offset:24576
    s_waitcnt lgkmcnt(15)
    v_mfma_f32_16x16x32_bf16 v[144:147], v[68:71], v[96:99], v[144:147]
    ds_read_b64_tr_b16 v[82:83], v60 offset:25600
    v_mfma_f32_16x16x32_bf16 v[148:151], v[68:71], v[100:103], v[148:151]
    v_mfma_f32_16x16x32_bf16 v[152:155], v[68:71], v[104:107], v[152:155]
    v_mfma_f32_16x16x32_bf16 v[156:159], v[68:71], v[108:111], v[156:159]
    ds_read_b64_tr_b16 v[68:69], v61 offset:8192
    s_waitcnt lgkmcnt(15)
    v_mfma_f32_16x16x32_bf16 v[208:211], v[84:87], v[96:99], v[208:211]
    ds_read_b64_tr_b16 v[70:71], v61 offset:9216
    v_mfma_f32_16x16x32_bf16 v[212:215], v[84:87], v[100:103], v[212:215]
    v_mfma_f32_16x16x32_bf16 v[216:219], v[84:87], v[104:107], v[216:219]
    v_mfma_f32_16x16x32_bf16 v[220:223], v[84:87], v[108:111], v[220:223]
    ds_read_b64_tr_b16 v[84:85], v61 offset:24576
    s_waitcnt lgkmcnt(5)
    v_mfma_f32_16x16x32_bf16 v[128:131], v[64:67], v[112:115], v[128:131]
    ds_read_b64_tr_b16 v[86:87], v61 offset:25600
    v_mfma_f32_16x16x32_bf16 v[132:135], v[64:67], v[116:119], v[132:135]
    v_mfma_f32_16x16x32_bf16 v[136:139], v[64:67], v[120:123], v[136:139]
    v_mfma_f32_16x16x32_bf16 v[140:143], v[64:67], v[124:127], v[140:143]
    s_waitcnt lgkmcnt(4)
    v_mfma_f32_16x16x32_bf16 v[192:195], v[80:83], v[112:115], v[192:195]
    v_mfma_f32_16x16x32_bf16 v[196:199], v[80:83], v[116:119], v[196:199]
    v_mfma_f32_16x16x32_bf16 v[200:203], v[80:83], v[120:123], v[200:203]
    v_mfma_f32_16x16x32_bf16 v[204:207], v[80:83], v[124:127], v[204:207]
    s_waitcnt lgkmcnt(2)
    v_mfma_f32_16x16x32_bf16 v[144:147], v[68:71], v[112:115], v[144:147]
    v_mfma_f32_16x16x32_bf16 v[148:151], v[68:71], v[116:119], v[148:151]
    v_mfma_f32_16x16x32_bf16 v[152:155], v[68:71], v[120:123], v[152:155]
    v_mfma_f32_16x16x32_bf16 v[156:159], v[68:71], v[124:127], v[156:159]
    s_waitcnt lgkmcnt(0)
    v_mfma_f32_16x16x32_bf16 v[208:211], v[84:87], v[112:115], v[208:211]
    v_mfma_f32_16x16x32_bf16 v[212:215], v[84:87], v[116:119], v[212:215]
    v_mfma_f32_16x16x32_bf16 v[216:219], v[84:87], v[120:123], v[216:219]
    v_mfma_f32_16x16x32_bf16 v[220:223], v[84:87], v[124:127], v[220:223]
    v_mfma_f32_16x16x32_bf16 v[160:163], v[72:75], v[96:99], v[160:163]
    v_mfma_f32_16x16x32_bf16 v[164:167], v[72:75], v[100:103], v[164:167]
    v_mfma_f32_16x16x32_bf16 v[168:171], v[72:75], v[104:107], v[168:171]
    v_mfma_f32_16x16x32_bf16 v[172:175], v[72:75], v[108:111], v[172:175]
    ds_read_b64_tr_b16 v[72:73], v60 offset:8448
    v_mfma_f32_16x16x32_bf16 v[224:227], v[88:91], v[96:99], v[224:227]
    ds_read_b64_tr_b16 v[74:75], v60 offset:9472
    v_mfma_f32_16x16x32_bf16 v[228:231], v[88:91], v[100:103], v[228:231]
    v_mul_f32 v128, v128, v192
    v_mul_f32 v129, v129, v193
    v_mul_f32 v130, v130, v194
    v_mul_f32 v131, v131, v195
    v_mfma_f32_16x16x32_bf16 v[232:235], v[88:91], v[104:107], v[232:235]
    v_cvt_pk_bf16_f32 v16, v128, v129
    v_cvt_pk_bf16_f32 v17, v130, v131
    v_mul_f32 v144, v144, v208
    v_mul_f32 v145, v145, v209
    v_mfma_f32_16x16x32_bf16 v[236:239], v[88:91], v[108:111], v[236:239]
    ds_read_b64_tr_b16 v[88:89], v60 offset:24832
    v_mul_f32 v146, v146, v210
    v_mul_f32 v147, v147, v211
    v_cvt_pk_bf16_f32 v18, v144, v145
    v_cvt_pk_bf16_f32 v19, v146, v147
    v_mfma_f32_16x16x32_bf16 v[176:179], v[76:79], v[96:99], v[176:179]
    ds_read_b64_tr_b16 v[90:91], v60 offset:25856
    buffer_store_dwordx4 v[16:19], v4, s[16:19], s71 offen offset:0 sc1
    v_mul_f32 v132, v132, v196
    v_mul_f32 v133, v133, v197
    v_mul_f32 v134, v134, v198
    v_mfma_f32_16x16x32_bf16 v[180:183], v[76:79], v[100:103], v[180:183]
    v_mul_f32 v135, v135, v199
    v_cvt_pk_bf16_f32 v20, v132, v133
    v_cvt_pk_bf16_f32 v21, v134, v135
    v_mul_f32 v148, v148, v212
    v_mfma_f32_16x16x32_bf16 v[184:187], v[76:79], v[104:107], v[184:187]
    v_mul_f32 v149, v149, v213
    v_mul_f32 v150, v150, v214
    v_mul_f32 v151, v151, v215
    v_cvt_pk_bf16_f32 v22, v148, v149
    v_mfma_f32_16x16x32_bf16 v[188:191], v[76:79], v[108:111], v[188:191]
    ds_read_b64_tr_b16 v[76:77], v61 offset:8448
    v_cvt_pk_bf16_f32 v23, v150, v151
    buffer_store_dwordx4 v[20:23], v4, s[16:19], s71 offen offset:1024 sc1
    v_mul_f32 v136, v136, v200
    v_mul_f32 v137, v137, v201
    v_mfma_f32_16x16x32_bf16 v[240:243], v[92:95], v[96:99], v[240:243]
    ds_read_b64_tr_b16 v[78:79], v61 offset:9472
    v_mul_f32 v138, v138, v202
    v_mul_f32 v139, v139, v203
    v_cvt_pk_bf16_f32 v24, v136, v137
    v_cvt_pk_bf16_f32 v25, v138, v139
    v_mfma_f32_16x16x32_bf16 v[244:247], v[92:95], v[100:103], v[244:247]
    v_mul_f32 v152, v152, v216
    v_mul_f32 v153, v153, v217
    v_mul_f32 v154, v154, v218
    v_mul_f32 v155, v155, v219
    v_mfma_f32_16x16x32_bf16 v[248:251], v[92:95], v[104:107], v[248:251]
    v_cvt_pk_bf16_f32 v26, v152, v153
    v_cvt_pk_bf16_f32 v27, v154, v155
    buffer_store_dwordx4 v[24:27], v4, s[16:19], s71 offen offset:2048 sc1
    v_mul_f32 v140, v140, v204
    v_mfma_f32_16x16x32_bf16 v[252:255], v[92:95], v[108:111], v[252:255]
    ds_read_b64_tr_b16 v[92:93], v61 offset:24832
    v_mul_f32 v141, v141, v205
    v_mul_f32 v142, v142, v206
    v_mul_f32 v143, v143, v207
    v_cvt_pk_bf16_f32 v28, v140, v141
    s_waitcnt lgkmcnt(5)
    v_mfma_f32_16x16x32_bf16 v[160:163], v[72:75], v[112:115], v[160:163]
    ds_read_b64_tr_b16 v[94:95], v61 offset:25856
    v_cvt_pk_bf16_f32 v29, v142, v143
    v_mul_f32 v156, v156, v220
    v_mul_f32 v157, v157, v221
    v_mul_f32 v158, v158, v222
    v_mfma_f32_16x16x32_bf16 v[164:167], v[72:75], v[116:119], v[164:167]
    v_mul_f32 v159, v159, v223
    v_cvt_pk_bf16_f32 v30, v156, v157
    v_cvt_pk_bf16_f32 v31, v158, v159
    buffer_store_dwordx4 v[28:31], v4, s[16:19], s71 offen offset:3072 sc1
    v_mfma_f32_16x16x32_bf16 v[168:171], v[72:75], v[120:123], v[168:171]
    v_mfma_f32_16x16x32_bf16 v[172:175], v[72:75], v[124:127], v[172:175]
    s_waitcnt lgkmcnt(4)
    v_mfma_f32_16x16x32_bf16 v[224:227], v[88:91], v[112:115], v[224:227]
    v_mfma_f32_16x16x32_bf16 v[228:231], v[88:91], v[116:119], v[228:231]
    v_mfma_f32_16x16x32_bf16 v[232:235], v[88:91], v[120:123], v[232:235]
    v_mfma_f32_16x16x32_bf16 v[236:239], v[88:91], v[124:127], v[236:239]
    s_waitcnt lgkmcnt(2)
    v_mfma_f32_16x16x32_bf16 v[176:179], v[76:79], v[112:115], v[176:179]
    v_mfma_f32_16x16x32_bf16 v[180:183], v[76:79], v[116:119], v[180:183]
    v_mfma_f32_16x16x32_bf16 v[184:187], v[76:79], v[120:123], v[184:187]
    v_mfma_f32_16x16x32_bf16 v[188:191], v[76:79], v[124:127], v[188:191]
    s_waitcnt lgkmcnt(0)
    v_mfma_f32_16x16x32_bf16 v[240:243], v[92:95], v[112:115], v[240:243]
    v_mfma_f32_16x16x32_bf16 v[244:247], v[92:95], v[116:119], v[244:247]
    v_mfma_f32_16x16x32_bf16 v[248:251], v[92:95], v[120:123], v[248:251]
    v_mfma_f32_16x16x32_bf16 v[252:255], v[92:95], v[124:127], v[252:255]
    s_nop 3
    v_mul_f32 v160, v160, v224
    v_mul_f32 v161, v161, v225
    v_mul_f32 v162, v162, v226
    v_mul_f32 v163, v163, v227
    v_cvt_pk_bf16_f32 v32, v160, v161
    v_cvt_pk_bf16_f32 v33, v162, v163
    v_mul_f32 v176, v176, v240
    v_mul_f32 v177, v177, v241
    v_mul_f32 v178, v178, v242
    v_mul_f32 v179, v179, v243
    v_cvt_pk_bf16_f32 v34, v176, v177
    v_cvt_pk_bf16_f32 v35, v178, v179
    buffer_store_dwordx4 v[32:35], v4, s[16:19], s72 offen offset:0 sc1
    v_mul_f32 v164, v164, v228
    v_mul_f32 v165, v165, v229
    v_mul_f32 v166, v166, v230
    v_mul_f32 v167, v167, v231
    v_cvt_pk_bf16_f32 v36, v164, v165
    v_cvt_pk_bf16_f32 v37, v166, v167
    v_mul_f32 v180, v180, v244
    v_mul_f32 v181, v181, v245
    v_mul_f32 v182, v182, v246
    v_mul_f32 v183, v183, v247
    v_cvt_pk_bf16_f32 v38, v180, v181
    v_cvt_pk_bf16_f32 v39, v182, v183
    buffer_store_dwordx4 v[36:39], v4, s[16:19], s72 offen offset:1024 sc1
    v_mul_f32 v168, v168, v232
    v_mul_f32 v169, v169, v233
    v_mul_f32 v170, v170, v234
    v_mul_f32 v171, v171, v235
    v_cvt_pk_bf16_f32 v40, v168, v169
    v_cvt_pk_bf16_f32 v41, v170, v171
    v_mul_f32 v184, v184, v248
    v_mul_f32 v185, v185, v249
    v_mul_f32 v186, v186, v250
    v_mul_f32 v187, v187, v251
    v_cvt_pk_bf16_f32 v42, v184, v185
    v_cvt_pk_bf16_f32 v43, v186, v187
    buffer_store_dwordx4 v[40:43], v4, s[16:19], s72 offen offset:2048 sc1
    v_mul_f32 v172, v172, v236
    v_mul_f32 v173, v173, v237
    v_mul_f32 v174, v174, v238
    v_mul_f32 v175, v175, v239
    v_cvt_pk_bf16_f32 v44, v172, v173
    v_cvt_pk_bf16_f32 v45, v174, v175
    v_mul_f32 v188, v188, v252
    v_mul_f32 v189, v189, v253
    v_mul_f32 v190, v190, v254
    v_mul_f32 v191, v191, v255
    v_cvt_pk_bf16_f32 v46, v188, v189
    v_cvt_pk_bf16_f32 v47, v190, v191
    buffer_store_dwordx4 v[44:47], v4, s[16:19], s72 offen offset:3072 sc1
    v_mov_b32 v173, 157696
    v_mov_b32 v175, 1
    s_mov_b64 exec, 1
    ds_add_u32 v173, v175 offset:4
    s_mov_b64 exec, -1
    s_mov_b32 s56, 0
L_lw_1:
    ds_read_b32 v1, v173 offset:20
    s_add_u32 s56, s56, 1
    s_waitcnt lgkmcnt(0)
    v_readfirstlane_b32 s57, v1
    s_cmp_ge_u32 s56, 0x100000
    s_cselect_b32 s57, 1, s57
    s_cmp_ge_u32 s57, 1
    s_cbranch_scc1 L_lwd_2
    s_sleep 1
    s_branch L_lw_1
L_lwd_2:
L_g2:
    s_mul_i32 s66, s60, 10240
    v_add_u32 v172, s66, v4
    v_add_u32 v174, 98304, v172
    buffer_load_dword v170, v7, s[16:19], 0 offen sc1
    v_mov_b32 v176, 0
    v_mov_b32 v177, 0
    v_mov_b32 v178, 0
    v_mov_b32 v179, 0
    v_mov_b32 v180, 0
    v_mov_b32 v181, 0
    v_mov_b32 v182, 0
    v_mov_b32 v183, 0
    v_mov_b32 v184, 0
    v_mov_b32 v185, 0
    v_mov_b32 v186, 0
    v_mov_b32 v187, 0
    v_mov_b32 v188, 0
    v_mov_b32 v189, 0
    v_mov_b32 v190, 0
    v_mov_b32 v191, 0
    v_mov_b32 v192, 0
    v_mov_b32 v193, 0
    v_mov_b32 v194, 0
    v_mov_b32 v195, 0
    v_mov_b32 v196, 0
    v_mov_b32 v197, 0
    v_mov_b32 v198, 0
    v_mov_b32 v199, 0
    v_mov_b32 v200, 0
    v_mov_b32 v201, 0
    v_mov_b32 v202, 0
    v_mov_b32 v203, 0
    v_mov_b32 v204, 0
    v_mov_b32 v205, 0
    v_mov_b32 v206, 0
    v_mov_b32 v207, 0
    v_mov_b32 v208, 0
    v_mov_b32 v209, 0
    v_mov_b32 v210, 0
    v_mov_b32 v211, 0
    v_mov_b32 v212, 0
    v_mov_b32 v213, 0
    v_mov_b32 v214, 0
    v_mov_b32 v215, 0
    v_mov_b32 v216, 0
    v_mov_b32 v217, 0
    v_mov_b32 v218, 0
    v_mov_b32 v219, 0
    v_mov_b32 v220, 0
    v_mov_b32 v221, 0
    v_mov_b32 v222, 0
    v_mov_b32 v223, 0
    v_mov_b32 v224, 0
    v_mov_b32 v225, 0
    v_mov_b32 v226, 0
    v_mov_b32 v227, 0
    v_mov_b32 v228, 0
    v_mov_b32 v229, 0
    v_mov_b32 v230, 0
    v_mov_b32 v231, 0
    v_mov_b32 v232, 0
    v_mov_b32 v233, 0
    v_mov_b32 v234, 0
    v_mov_b32 v235, 0
    v_mov_b32 v236, 0
    v_mov_b32 v237, 0
    v_mov_b32 v238, 0
    v_mov_b32 v239, 0
    v_mov_b32 v240, 0
    v_mov_b32 v241, 0
    v_mov_b32 v242, 0
    v_mov_b32 v243, 0
    v_mov_b32 v244, 0
    v_mov_b32 v245, 0
    v_mov_b32 v246, 0
    v_mov_b32 v247, 0
    v_mov_b32 v248, 0
    v_mov_b32 v249, 0
    v_mov_b32 v250, 0
    v_mov_b32 v251, 0
    v_mov_b32 v252, 0
    v_mov_b32 v253, 0
    v_mov_b32 v254, 0
    v_mov_b32 v255, 0
    s_waitcnt vmcnt(0)
    v_mov_b32 v1, s61
    v_mov_b32 v2, 0
    s_mov_b64 exec, 1
    buffer_store_dword v1, v2, s[16:19], s73 offen sc1
    s_mov_b64 exec, -1
    s_setprio 0
    s_mul_i32 s79, s77, 5120
    s_add_u32 s79, s79, s75
    s_add_u32 s77, s77, s78
    s_cmp_ge_u32 s77, 12
    s_cselect_b32 s66, 12, 0
    s_sub_u32 s77, s77, s66
    buffer_load_dwordx4 v[8:11], v4, s[16:19], s79 offen offset:0 sc1
    buffer_load_dwordx4 v[12:15], v4, s[16:19], s79 offen offset:1024 sc1
    buffer_load_dwordx4 v[16:19], v4, s[16:19], s79 offen offset:2048 sc1
    buffer_load_dwordx4 v[20:23], v4, s[16:19], s79 offen offset:3072 sc1
    buffer_load_dwordx4 v[24:27], v5, s[16:19], s79 offen sc1
    s_mul_i32 s79, s77, 5120
    s_add_u32 s79, s79, s75
    s_add_u32 s77, s77, s78
    s_cmp_ge_u32 s77, 12
    s_cselect_b32 s66, 12, 0
    s_sub_u32 s77, s77, s66
    buffer_load_dwordx4 v[28:31], v4, s[16:19], s79 offen offset:0 sc1
    buffer_load_dwordx4 v[32:35], v4, s[16:19], s79 offen offset:1024 sc1
    buffer_load_dwordx4 v[36:39], v4, s[16:19], s79 offen offset:2048 sc1
    buffer_load_dwordx4 v[40:43], v4, s[16:19], s79 offen offset:3072 sc1
    buffer_load_dwordx4 v[44:47], v5, s[16:19], s79 offen sc1
    s_mul_i32 s79, s77, 5120
    s_add_u32 s79, s79, s75
    s_add_u32 s77, s77, s78
    s_cmp_ge_u32 s77, 12
    s_cselect_b32 s66, 12, 0
    s_sub_u32 s77, s77, s66
    buffer_load_dwordx4 v[48:51], v4, s[16:19], s79 offen offset:0 sc1
    buffer_load_dwordx4 v[52:55], v4, s[16:19], s79 offen offset:1024 sc1
    buffer_load_dwordx4 v[56:59], v4, s[16:19], s79 offen offset:2048 sc1
    buffer_load_dwordx4 v[60:63], v4, s[16:19], s79 offen offset:3072 sc1
    buffer_load_dwordx4 v[64:67], v5, s[16:19], s79 offen sc1
    s_mul_i32 s79, s77, 5120
    s_add_u32 s79, s79, s75
    s_add_u32 s77, s77, s78
    s_cmp_ge_u32 s77, 12
    s_cselect_b32 s66, 12, 0
    s_sub_u32 s77, s77, s66
    s_add_u32 s77, s77, s78
    s_cmp_ge_u32 s77, 12
    s_cselect_b32 s66, 12, 0
    s_sub_u32 s77, s77, s66
    s_add_u32 s77, s77, s78
    s_cmp_ge_u32 s77, 12
    s_cselect_b32 s66, 12, 0
    s_sub_u32 s77, s77, s66
    s_add_u32 s77, s77, s78
    s_cmp_ge_u32 s77, 12
    s_cselect_b32 s66, 12, 0
    s_sub_u32 s77, s77, s66
    s_add_u32 s77, s77, s78
    s_cmp_ge_u32 s77, 12
    s_cselect_b32 s66, 12, 0
    s_sub_u32 s77, s77, s66
    buffer_load_dwordx4 v[68:71], v4, s[16:19], s79 offen offset:0 sc1
    buffer_load_dwordx4 v[72:75], v4, s[16:19], s79 offen offset:1024 sc1
    buffer_load_dwordx4 v[76:79], v4, s[16:19], s79 offen offset:2048 sc1
    buffer_load_dwordx4 v[80:83], v4, s[16:19], s79 offen offset:3072 sc1
    buffer_load_dwordx4 v[84:87], v5, s[16:19], s79 offen sc1
    v_cmp_ne_u32 vcc, s61, v170
    s_cmp_eq_u64 vcc, 0
    s_cbranch_scc1 L_hready
    s_mov_b32 s64, 0
L_poll_3:
    buffer_load_dword v1, v7, s[16:19], 0 offen sc1
    s_waitcnt vmcnt(0)
    v_xor_b32 v1, s61, v1
    v_cmp_ne_u32 vcc, 0, v1
    s_add_u32 s64, s64, 1
    s_cmp_eq_u64 vcc, 0
    s_cbranch_scc1 L_pdone_4
    s_sleep 2
    s_cmp_lt_u32 s64, 0x8000
    s_cbranch_scc1 L_poll_3
L_pdone_4:
L_hready:
    s_lshl_b32 s79, s76, 12
    s_add_u32 s79, s79, s74
    s_add_u32 s76, s76, s78
    s_cmp_ge_u32 s76, 12
    s_cselect_b32 s66, 12, 0
    s_sub_u32 s76, s76, s66
    buffer_load_dwordx4 v[108:111], v4, s[16:19], s79 offen offset:0 sc1
    buffer_load_dwordx4 v[112:115], v4, s[16:19], s79 offen offset:1024 sc1
    buffer_load_dwordx4 v[116:119], v4, s[16:19], s79 offen offset:2048 sc1
    buffer_load_dwordx4 v[120:123], v4, s[16:19], s79 offen offset:3072 sc1
    s_lshl_b32 s79, s76, 12
    s_add_u32 s79, s79, s74
    s_add_u32 s76, s76, s78
    s_cmp_ge_u32 s76, 12
    s_cselect_b32 s66, 12, 0
    s_sub_u32 s76, s76, s66
    buffer_load_dwordx4 v[124:127], v4, s[16:19], s79 offen offset:0 sc1
    buffer_load_dwordx4 v[128:131], v4, s[16:19], s79 offen offset:1024 sc1
    buffer_load_dwordx4 v[132:135], v4, s[16:19], s79 offen offset:2048 sc1
    buffer_load_dwordx4 v[136:139], v4, s[16:19], s79 offen offset:3072 sc1
    s_lshl_b32 s79, s76, 12
    s_add_u32 s79, s79, s74
    s_add_u32 s76, s76, s78
    s_cmp_ge_u32 s76, 12
    s_cselect_b32 s66, 12, 0
    s_sub_u32 s76, s76, s66
    buffer_load_dwordx4 v[140:143], v4, s[16:19], s79 offen offset:0 sc1
    buffer_load_dwordx4 v[144:147], v4, s[16:19], s79 offen offset:1024 sc1
    buffer_load_dwordx4 v[148:151], v4, s[16:19], s79 offen offset:2048 sc1
    buffer_load_dwordx4 v[152:155], v4, s[16:19], s79 offen offset:3072 sc1
    s_lshl_b32 s79, s76, 12
    s_add_u32 s79, s79, s74
    s_add_u32 s76, s76, s78
    s_cmp_ge_u32 s76, 12
    s_cselect_b32 s66, 12, 0
    s_sub_u32 s76, s76, s66
    buffer_load_dwordx4 v[156:159], v4, s[16:19], s79 offen offset:0 sc1
    buffer_load_dwordx4 v[160:163], v4, s[16:19], s79 offen offset:1024 sc1
    buffer_load_dwordx4 v[164:167], v4, s[16:19], s79 offen offset:2048 sc1
    buffer_load_dwordx4 v[168:171], v4, s[16:19], s79 offen offset:3072 sc1
    v_mov_b32 v1, 1
    s_mov_b64 exec, 1
    ds_add_u32 v173, v1 offset:4
    s_mov_b64 exec, -1
    s_waitcnt vmcnt(12)
    v_mfma_f32_16x16x32_bf16 v[176:179], v[8:11], v[108:111], v[176:179]
    v_mfma_f32_16x16x32_bf16 v[180:183], v[8:11], v[112:115], v[180:183]
    v_mfma_f32_16x16x32_bf16 v[184:187], v[8:11], v[116:119], v[184:187]
    v_mfma_f32_16x16x32_bf16 v[188:191], v[8:11], v[120:123], v[188:191]
    v_mfma_f32_16x16x32_bf16 v[192:195], v[12:15], v[108:111], v[192:195]
    v_mfma_f32_16x16x32_bf16 v[196:199], v[12:15], v[112:115], v[196:199]
    v_mfma_f32_16x16x32_bf16 v[200:203], v[12:15], v[116:119], v[200:203]
    v_mfma_f32_16x16x32_bf16 v[204:207], v[12:15], v[120:123], v[204:207]
    v_mfma_f32_16x16x32_bf16 v[208:211], v[16:19], v[108:111], v[208:211]
    v_mfma_f32_16x16x32_bf16 v[212:215], v[16:19], v[112:115], v[212:215]
    v_mfma_f32_16x16x32_bf16 v[216:219], v[16:19], v[116:119], v[216:219]
    v_mfma_f32_16x16x32_bf16 v[220:223], v[16:19], v[120:123], v[220:223]
    v_mfma_f32_16x16x32_bf16 v[224:227], v[20:23], v[108:111], v[224:227]
    v_mfma_f32_16x16x32_bf16 v[228:231], v[20:23], v[112:115], v[228:231]
    v_mfma_f32_16x16x32_bf16 v[232:235], v[20:23], v[116:119], v[232:235]
    v_mfma_f32_16x16x32_bf16 v[236:239], v[20:23], v[120:123], v[236:239]
    v_mfma_f32_16x16x32_bf16 v[240:243], v[24:27], v[108:111], v[240:243]
    v_mfma_f32_16x16x32_bf16 v[244:247], v[24:27], v[112:115], v[244:247]
    v_mfma_f32_16x16x32_bf16 v[248:251], v[24:27], v[116:119], v[248:251]
    v_mfma_f32_16x16x32_bf16 v[252:255], v[24:27], v[120:123], v[252:255]
    s_lshl_b32 s79, s76, 12
    s_add_u32 s79, s79, s74
    s_add_u32 s76, s76, s78
    s_cmp_ge_u32 s76, 12
    s_cselect_b32 s66, 12, 0
    s_sub_u32 s76, s76, s66
    buffer_load_dwordx4 v[108:111], v4, s[16:19], s79 offen offset:0 sc1
    buffer_load_dwordx4 v[112:115], v4, s[16:19], s79 offen offset:1024 sc1
    buffer_load_dwordx4 v[116:119], v4, s[16:19], s79 offen offset:2048 sc1
    buffer_load_dwordx4 v[120:123], v4, s[16:19], s79 offen offset:3072 sc1
    s_waitcnt vmcnt(12)
    v_mfma_f32_16x16x32_bf16 v[176:179], v[28:31], v[124:127], v[176:179]
    v_mfma_f32_16x16x32_bf16 v[180:183], v[28:31], v[128:131], v[180:183]
    v_mfma_f32_16x16x32_bf16 v[184:187], v[28:31], v[132:135], v[184:187]
    v_mfma_f32_16x16x32_bf16 v[188:191], v[28:31], v[136:139], v[188:191]
    v_mfma_f32_16x16x32_bf16 v[192:195], v[32:35], v[124:127], v[192:195]
    v_mfma_f32_16x16x32_bf16 v[196:199], v[32:35], v[128:131], v[196:199]
    v_mfma_f32_16x16x32_bf16 v[200:203], v[32:35], v[132:135], v[200:203]
    v_mfma_f32_16x16x32_bf16 v[204:207], v[32:35], v[136:139], v[204:207]
    v_mfma_f32_16x16x32_bf16 v[208:211], v[36:39], v[124:127], v[208:211]
    v_mfma_f32_16x16x32_bf16 v[212:215], v[36:39], v[128:131], v[212:215]
    v_mfma_f32_16x16x32_bf16 v[216:219], v[36:39], v[132:135], v[216:219]
    v_mfma_f32_16x16x32_bf16 v[220:223], v[36:39], v[136:139], v[220:223]
    v_mfma_f32_16x16x32_bf16 v[224:227], v[40:43], v[124:127], v[224:227]
    v_mfma_f32_16x16x32_bf16 v[228:231], v[40:43], v[128:131], v[228:231]
    v_mfma_f32_16x16x32_bf16 v[232:235], v[40:43], v[132:135], v[232:235]
    v_mfma_f32_16x16x32_bf16 v[236:239], v[40:43], v[136:139], v[236:239]
    v_mfma_f32_16x16x32_bf16 v[240:243], v[44:47], v[124:127], v[240:243]
    v_mfma_f32_16x16x32_bf16 v[244:247], v[44:47], v[128:131], v[244:247]
    v_mfma_f32_16x16x32_bf16 v[248:251], v[44:47], v[132:135], v[248:251]
    v_mfma_f32_16x16x32_bf16 v[252:255], v[44:47], v[136:139], v[252:255]
    s_lshl_b32 s79, s76, 12
    s_add_u32 s79, s79, s74
    s_add_u32 s76, s76, s78
    s_cmp_ge_u32 s76, 12
    s_cselect_b32 s66, 12, 0
    s_sub_u32 s76, s76, s66
    buffer_load_dwordx4 v[124:127], v4, s[16:19], s79 offen offset:0 sc1
    buffer_load_dwordx4 v[128:131], v4, s[16:19], s79 offen offset:1024 sc1
    buffer_load_dwordx4 v[132:135], v4, s[16:19], s79 offen offset:2048 sc1
    buffer_load_dwordx4 v[136:139], v4, s[16:19], s79 offen offset:3072 sc1
    s_waitcnt vmcnt(12)
    v_mfma_f32_16x16x32_bf16 v[176:179], v[48:51], v[140:143], v[176:179]
    v_mfma_f32_16x16x32_bf16 v[180:183], v[48:51], v[144:147], v[180:183]
    v_mfma_f32_16x16x32_bf16 v[184:187], v[48:51], v[148:151], v[184:187]
    v_mfma_f32_16x16x32_bf16 v[188:191], v[48:51], v[152:155], v[188:191]
    v_mfma_f32_16x16x32_bf16 v[192:195], v[52:55], v[140:143], v[192:195]
    v_mfma_f32_16x16x32_bf16 v[196:199], v[52:55], v[144:147], v[196:199]
    v_mfma_f32_16x16x32_bf16 v[200:203], v[52:55], v[148:151], v[200:203]
    v_mfma_f32_16x16x32_bf16 v[204:207], v[52:55], v[152:155], v[204:207]
    v_mfma_f32_16x16x32_bf16 v[208:211], v[56:59], v[140:143], v[208:211]
    v_mfma_f32_16x16x32_bf16 v[212:215], v[56:59], v[144:147], v[212:215]
    v_mfma_f32_16x16x32_bf16 v[216:219], v[56:59], v[148:151], v[216:219]
    v_mfma_f32_16x16x32_bf16 v[220:223], v[56:59], v[152:155], v[220:223]
    v_mfma_f32_16x16x32_bf16 v[224:227], v[60:63], v[140:143], v[224:227]
    v_mfma_f32_16x16x32_bf16 v[228:231], v[60:63], v[144:147], v[228:231]
    v_mfma_f32_16x16x32_bf16 v[232:235], v[60:63], v[148:151], v[232:235]
    v_mfma_f32_16x16x32_bf16 v[236:239], v[60:63], v[152:155], v[236:239]
    v_mfma_f32_16x16x32_bf16 v[240:243], v[64:67], v[140:143], v[240:243]
    v_mfma_f32_16x16x32_bf16 v[244:247], v[64:67], v[144:147], v[244:247]
    v_mfma_f32_16x16x32_bf16 v[248:251], v[64:67], v[148:151], v[248:251]
    v_mfma_f32_16x16x32_bf16 v[252:255], v[64:67], v[152:155], v[252:255]
    s_lshl_b32 s79, s76, 12
    s_add_u32 s79, s79, s74
    s_add_u32 s76, s76, s78
    s_cmp_ge_u32 s76, 12
    s_cselect_b32 s66, 12, 0
    s_sub_u32 s76, s76, s66
    buffer_load_dwordx4 v[140:143], v4, s[16:19], s79 offen offset:0 sc1
    buffer_load_dwordx4 v[144:147], v4, s[16:19], s79 offen offset:1024 sc1
    buffer_load_dwordx4 v[148:151], v4, s[16:19], s79 offen offset:2048 sc1
    buffer_load_dwordx4 v[152:155], v4, s[16:19], s79 offen offset:3072 sc1
    s_waitcnt vmcnt(12)
    s_mov_b32 s56, 0
L_lw_5:
    ds_read_b32 v1, v173 offset:0
    s_add_u32 s56, s56, 1
    s_waitcnt lgkmcnt(0)
    v_readfirstlane_b32 s57, v1
    s_cmp_ge_u32 s56, 0x100000
    s_cselect_b32 s57, 1, s57
    s_cmp_ge_u32 s57, 1
    s_cbranch_scc0 L_lw_5
    ds_read_b128 v[88:91], v174 offset:0
    ds_read_b128 v[92:95], v174 offset:1024
    ds_read_b128 v[96:99], v174 offset:2048
    ds_read_b128 v[100:103], v174 offset:3072
    ds_read_b128 v[104:107], v174 offset:4096
    v_mfma_f32_16x16x32_bf16 v[176:179], v[68:71], v[156:159], v[176:179]
    v_mfma_f32_16x16x32_bf16 v[180:183], v[68:71], v[160:163], v[180:183]
    v_mfma_f32_16x16x32_bf16 v[184:187], v[68:71], v[164:167], v[184:187]
    v_mfma_f32_16x16x32_bf16 v[188:191], v[68:71], v[168:171], v[188:191]
    v_mfma_f32_16x16x32_bf16 v[192:195], v[72:75], v[156:159], v[192:195]
    v_mfma_f32_16x16x32_bf16 v[196:199], v[72:75], v[160:163], v[196:199]
    v_mfma_f32_16x16x32_bf16 v[200:203], v[72:75], v[164:167], v[200:203]
    v_mfma_f32_16x16x32_bf16 v[204:207], v[72:75], v[168:171], v[204:207]
    v_mfma_f32_16x16x32_bf16 v[208:211], v[76:79], v[156:159], v[208:211]
    v_mfma_f32_16x16x32_bf16 v[212:215], v[76:79], v[160:163], v[212:215]
    v_mfma_f32_16x16x32_bf16 v[216:219], v[76:79], v[164:167], v[216:219]
    v_mfma_f32_16x16x32_bf16 v[220:223], v[76:79], v[168:171], v[220:223]
    v_mfma_f32_16x16x32_bf16 v[224:227], v[80:83], v[156:159], v[224:227]
    v_mfma_f32_16x16x32_bf16 v[228:231], v[80:83], v[160:163], v[228:231]
    v_mfma_f32_16x16x32_bf16 v[232:235], v[80:83], v[164:167], v[232:235]
    v_mfma_f32_16x16x32_bf16 v[236:239], v[80:83], v[168:171], v[236:239]
    v_mfma_f32_16x16x32_bf16 v[240:243], v[84:87], v[156:159], v[240:243]
    v_mfma_f32_16x16x32_bf16 v[244:247], v[84:87], v[160:163], v[244:247]
    v_mfma_f32_16x16x32_bf16 v[248:251], v[84:87], v[164:167], v[248:251]
    v_mfma_f32_16x16x32_bf16 v[252:255], v[84:87], v[168:171], v[252:255]
    s_lshl_b32 s79, s76, 12
    s_add_u32 s79, s79, s74
    s_add_u32 s76, s76, s78
    s_cmp_ge_u32 s76, 12
    s_cselect_b32 s66, 12, 0
    s_sub_u32 s76, s76, s66
    buffer_load_dwordx4 v[156:159], v4, s[16:19], s79 offen offset:0 sc1
    buffer_load_dwordx4 v[160:163], v4, s[16:19], s79 offen offset:1024 sc1
    buffer_load_dwordx4 v[164:167], v4, s[16:19], s79 offen offset:2048 sc1
    buffer_load_dwordx4 v[168:171], v4, s[16:19], s79 offen offset:3072 sc1
    s_mul_i32 s79, s77, 5120
    s_add_u32 s79, s79, s75
    s_add_u32 s77, s77, s78
    s_cmp_ge_u32 s77, 12
    s_cselect_b32 s66, 12, 0
    s_sub_u32 s77, s77, s66
    buffer_load_dwordx4 v[8:11], v4, s[16:19], s79 offen offset:0 sc1
    buffer_load_dwordx4 v[12:15], v4, s[16:19], s79 offen offset:1024 sc1
    buffer_load_dwordx4 v[16:19], v4, s[16:19], s79 offen offset:2048 sc1
    buffer_load_dwordx4 v[20:23], v4, s[16:19], s79 offen offset:3072 sc1
    buffer_load_dwordx4 v[24:27], v5, s[16:19], s79 offen sc1
    s_waitcnt vmcnt(17)
    s_waitcnt lgkmcnt(4)
    v_mfma_f32_16x16x32_bf16 v[176:179], v[88:91], v[108:111], v[176:179]
    v_mfma_f32_16x16x32_bf16 v[180:183], v[88:91], v[112:115], v[180:183]
    v_mfma_f32_16x16x32_bf16 v[184:187], v[88:91], v[116:119], v[184:187]
    v_mfma_f32_16x16x32_bf16 v[188:191], v[88:91], v[120:123], v[188:191]
    ds_read_b128 v[88:91], v174 offset:5120
    s_waitcnt lgkmcnt(4)
    v_mfma_f32_16x16x32_bf16 v[192:195], v[92:95], v[108:111], v[192:195]
    v_mfma_f32_16x16x32_bf16 v[196:199], v[92:95], v[112:115], v[196:199]
    v_mfma_f32_16x16x32_bf16 v[200:203], v[92:95], v[116:119], v[200:203]
    v_mfma_f32_16x16x32_bf16 v[204:207], v[92:95], v[120:123], v[204:207]
    ds_read_b128 v[92:95], v174 offset:6144
    s_waitcnt lgkmcnt(4)
    v_mfma_f32_16x16x32_bf16 v[208:211], v[96:99], v[108:111], v[208:211]
    v_mfma_f32_16x16x32_bf16 v[212:215], v[96:99], v[112:115], v[212:215]
    v_mfma_f32_16x16x32_bf16 v[216:219], v[96:99], v[116:119], v[216:219]
    v_mfma_f32_16x16x32_bf16 v[220:223], v[96:99], v[120:123], v[220:223]
    ds_read_b128 v[96:99], v174 offset:7168
    s_waitcnt lgkmcnt(4)
    v_mfma_f32_16x16x32_bf16 v[224:227], v[100:103], v[108:111], v[224:227]
    v_mfma_f32_16x16x32_bf16 v[228:231], v[100:103], v[112:115], v[228:231]
    v_mfma_f32_16x16x32_bf16 v[232:235], v[100:103], v[116:119], v[232:235]
    v_mfma_f32_16x16x32_bf16 v[236:239], v[100:103], v[120:123], v[236:239]
    ds_read_b128 v[100:103], v174 offset:8192
    s_waitcnt lgkmcnt(4)
    v_mfma_f32_16x16x32_bf16 v[240:243], v[104:107], v[108:111], v[240:243]
    v_mfma_f32_16x16x32_bf16 v[244:247], v[104:107], v[112:115], v[244:247]
    v_mfma_f32_16x16x32_bf16 v[248:251], v[104:107], v[116:119], v[248:251]
    v_mfma_f32_16x16x32_bf16 v[252:255], v[104:107], v[120:123], v[252:255]
    ds_read_b128 v[104:107], v174 offset:9216
    s_lshl_b32 s79, s76, 12
    s_add_u32 s79, s79, s74
    s_add_u32 s76, s76, s78
    s_cmp_ge_u32 s76, 12
    s_cselect_b32 s66, 12, 0
    s_sub_u32 s76, s76, s66
    buffer_load_dwordx4 v[108:111], v4, s[16:19], s79 offen offset:0 sc1
    buffer_load_dwordx4 v[112:115], v4, s[16:19], s79 offen offset:1024 sc1
    buffer_load_dwordx4 v[116:119], v4, s[16:19], s79 offen offset:2048 sc1
    buffer_load_dwordx4 v[120:123], v4, s[16:19], s79 offen offset:3072 sc1
    s_mul_i32 s79, s77, 5120
    s_add_u32 s79, s79, s75
    s_add_u32 s77, s77, s78
    s_cmp_ge_u32 s77, 12
    s_cselect_b32 s66, 12, 0
    s_sub_u32 s77, s77, s66
    buffer_load_dwordx4 v[28:31], v4, s[16:19], s79 offen offset:0 sc1
    buffer_load_dwordx4 v[32:35], v4, s[16:19], s79 offen offset:1024 sc1
    buffer_load_dwordx4 v[36:39], v4, s[16:19], s79 offen offset:2048 sc1
    buffer_load_dwordx4 v[40:43], v4, s[16:19], s79 offen offset:3072 sc1
    buffer_load_dwordx4 v[44:47], v5, s[16:19], s79 offen sc1
    s_waitcnt vmcnt(22)
    s_waitcnt lgkmcnt(4)
    v_mfma_f32_16x16x32_bf16 v[176:179], v[88:91], v[124:127], v[176:179]
    v_mfma_f32_16x16x32_bf16 v[180:183], v[88:91], v[128:131], v[180:183]
    v_mfma_f32_16x16x32_bf16 v[184:187], v[88:91], v[132:135], v[184:187]
    v_mfma_f32_16x16x32_bf16 v[188:191], v[88:91], v[136:139], v[188:191]
    s_mov_b32 s56, 0
L_lw_6:
    ds_read_b32 v1, v173 offset:0
    s_add_u32 s56, s56, 1
    s_waitcnt lgkmcnt(0)
    v_readfirstlane_b32 s57, v1
    s_cmp_ge_u32 s56, 0x100000
    s_cselect_b32 s57, 2, s57
    s_cmp_ge_u32 s57, 2
    s_cbranch_scc0 L_lw_6
    ds_read_b128 v[88:91], v172 offset:0
    v_mfma_f32_16x16x32_bf16 v[192:195], v[92:95], v[124:127], v[192:195]
    v_mfma_f32_16x16x32_bf16 v[196:199], v[92:95], v[128:131], v[196:199]
    v_mfma_f32_16x16x32_bf16 v[200:203], v[92:95], v[132:135], v[200:203]
    v_mfma_f32_16x16x32_bf16 v[204:207], v[92:95], v[136:139], v[204:207]
    ds_read_b128 v[92:95], v172 offset:1024
    v_mfma_f32_16x16x32_bf16 v[208:211], v[96:99], v[124:127], v[208:211]
    v_mfma_f32_16x16x32_bf16 v[212:215], v[96:99], v[128:131], v[212:215]
    v_mfma_f32_16x16x32_bf16 v[216:219], v[96:99], v[132:135], v[216:219]
    v_mfma_f32_16x16x32_bf16 v[220:223], v[96:99], v[136:139], v[220:223]
    ds_read_b128 v[96:99], v172 offset:2048
    v_mfma_f32_16x16x32_bf16 v[224:227], v[100:103], v[124:127], v[224:227]
    v_mfma_f32_16x16x32_bf16 v[228:231], v[100:103], v[128:131], v[228:231]
    v_mfma_f32_16x16x32_bf16 v[232:235], v[100:103], v[132:135], v[232:235]
    v_mfma_f32_16x16x32_bf16 v[236:239], v[100:103], v[136:139], v[236:239]
    ds_read_b128 v[100:103], v172 offset:3072
    v_mfma_f32_16x16x32_bf16 v[240:243], v[104:107], v[124:127], v[240:243]
    v_mfma_f32_16x16x32_bf16 v[244:247], v[104:107], v[128:131], v[244:247]
    v_mfma_f32_16x16x32_bf16 v[248:251], v[104:107], v[132:135], v[248:251]
    v_mfma_f32_16x16x32_bf16 v[252:255], v[104:107], v[136:139], v[252:255]
    ds_read_b128 v[104:107], v172 offset:4096
    s_lshl_b32 s79, s76, 12
    s_add_u32 s79, s79, s74
    s_add_u32 s76, s76, s78
    s_cmp_ge_u32 s76, 12
    s_cselect_b32 s66, 12, 0
    s_sub_u32 s76, s76, s66
    buffer_load_dwordx4 v[124:127], v4, s[16:19], s79 offen offset:0 sc1
    buffer_load_dwordx4 v[128:131], v4, s[16:19], s79 offen offset:1024 sc1
    buffer_load_dwordx4 v[132:135], v4, s[16:19], s79 offen offset:2048 sc1
    buffer_load_dwordx4 v[136:139], v4, s[16:19], s79 offen offset:3072 sc1
    s_mul_i32 s79, s77, 5120
    s_add_u32 s79, s79, s75
    s_add_u32 s77, s77, s78
    s_cmp_ge_u32 s77, 12
    s_cselect_b32 s66, 12, 0
    s_sub_u32 s77, s77, s66
    buffer_load_dwordx4 v[48:51], v4, s[16:19], s79 offen offset:0 sc1
    buffer_load_dwordx4 v[52:55], v4, s[16:19], s79 offen offset:1024 sc1
    buffer_load_dwordx4 v[56:59], v4, s[16:19], s79 offen offset:2048 sc1
    buffer_load_dwordx4 v[60:63], v4, s[16:19], s79 offen offset:3072 sc1
    buffer_load_dwordx4 v[64:67], v5, s[16:19], s79 offen sc1
    v_mov_b32 v1, 1
    s_mov_b64 exec, 1
    ds_add_u32 v173, v1 offset:4
    s_mov_b64 exec, -1
    s_waitcnt vmcnt(27)
    s_waitcnt lgkmcnt(5)
    v_mfma_f32_16x16x32_bf16 v[176:179], v[88:91], v[140:143], v[176:179]
    v_mfma_f32_16x16x32_bf16 v[180:183], v[88:91], v[144:147], v[180:183]
    v_mfma_f32_16x16x32_bf16 v[184:187], v[88:91], v[148:151], v[184:187]
    v_mfma_f32_16x16x32_bf16 v[188:191], v[88:91], v[152:155], v[188:191]
    ds_read_b128 v[88:91], v172 offset:5120
    s_waitcnt lgkmcnt(5)
    v_mfma_f32_16x16x32_bf16 v[192:195], v[92:95], v[140:143], v[192:195]
    v_mfma_f32_16x16x32_bf16 v[196:199], v[92:95], v[144:147], v[196:199]
    v_mfma_f32_16x16x32_bf16 v[200:203], v[92:95], v[148:151], v[200:203]
    v_mfma_f32_16x16x32_bf16 v[204:207], v[92:95], v[152:155], v[204:207]
    ds_read_b128 v[92:95], v172 offset:6144
    s_waitcnt lgkmcnt(5)
    v_mfma_f32_16x16x32_bf16 v[208:211], v[96:99], v[140:143], v[208:211]
    v_mfma_f32_16x16x32_bf16 v[212:215], v[96:99], v[144:147], v[212:215]
    v_mfma_f32_16x16x32_bf16 v[216:219], v[96:99], v[148:151], v[216:219]
    v_mfma_f32_16x16x32_bf16 v[220:223], v[96:99], v[152:155], v[220:223]
    ds_read_b128 v[96:99], v172 offset:7168
    s_waitcnt lgkmcnt(5)
    v_mfma_f32_16x16x32_bf16 v[224:227], v[100:103], v[140:143], v[224:227]
    v_mfma_f32_16x16x32_bf16 v[228:231], v[100:103], v[144:147], v[228:231]
    v_mfma_f32_16x16x32_bf16 v[232:235], v[100:103], v[148:151], v[232:235]
    v_mfma_f32_16x16x32_bf16 v[236:239], v[100:103], v[152:155], v[236:239]
    ds_read_b128 v[100:103], v172 offset:8192
    s_waitcnt lgkmcnt(5)
    v_mfma_f32_16x16x32_bf16 v[240:243], v[104:107], v[140:143], v[240:243]
    v_mfma_f32_16x16x32_bf16 v[244:247], v[104:107], v[144:147], v[244:247]
    v_mfma_f32_16x16x32_bf16 v[248:251], v[104:107], v[148:151], v[248:251]
    v_mfma_f32_16x16x32_bf16 v[252:255], v[104:107], v[152:155], v[252:255]
    ds_read_b128 v[104:107], v172 offset:9216
    s_lshl_b32 s79, s76, 12
    s_add_u32 s79, s79, s74
    s_add_u32 s76, s76, s78
    s_cmp_ge_u32 s76, 12
    s_cselect_b32 s66, 12, 0
    s_sub_u32 s76, s76, s66
    buffer_load_dwordx4 v[140:143], v4, s[16:19], s79 offen offset:0 sc1
    buffer_load_dwordx4 v[144:147], v4, s[16:19], s79 offen offset:1024 sc1
    buffer_load_dwordx4 v[148:151], v4, s[16:19], s79 offen offset:2048 sc1
    buffer_load_dwordx4 v[152:155], v4, s[16:19], s79 offen offset:3072 sc1
    s_mul_i32 s79, s77, 5120
    s_add_u32 s79, s79, s75
    s_add_u32 s77, s77, s78
    s_cmp_ge_u32 s77, 12
    s_cselect_b32 s66, 12, 0
    s_sub_u32 s77, s77, s66
    buffer_load_dwordx4 v[68:71], v4, s[16:19], s79 offen offset:0 sc1
    buffer_load_dwordx4 v[72:75], v4, s[16:19], s79 offen offset:1024 sc1
    buffer_load_dwordx4 v[76:79], v4, s[16:19], s79 offen offset:2048 sc1
    buffer_load_dwordx4 v[80:83], v4, s[16:19], s79 offen offset:3072 sc1
    buffer_load_dwordx4 v[84:87], v5, s[16:19], s79 offen sc1
    s_waitcnt vmcnt(32)
    s_waitcnt lgkmcnt(4)
    v_mfma_f32_16x16x32_bf16 v[176:179], v[88:91], v[156:159], v[176:179]
    v_mfma_f32_16x16x32_bf16 v[180:183], v[88:91], v[160:163], v[180:183]
    v_mfma_f32_16x16x32_bf16 v[184:187], v[88:91], v[164:167], v[184:187]
    v_mfma_f32_16x16x32_bf16 v[188:191], v[88:91], v[168:171], v[188:191]
    s_waitcnt lgkmcnt(3)
    v_mfma_f32_16x16x32_bf16 v[192:195], v[92:95], v[156:159], v[192:195]
    v_mfma_f32_16x16x32_bf16 v[196:199], v[92:95], v[160:163], v[196:199]
    v_mfma_f32_16x16x32_bf16 v[200:203], v[92:95], v[164:167], v[200:203]
    v_mfma_f32_16x16x32_bf16 v[204:207], v[92:95], v[168:171], v[204:207]
    s_waitcnt lgkmcnt(2)
    v_mfma_f32_16x16x32_bf16 v[208:211], v[96:99], v[156:159], v[208:211]
    v_mfma_f32_16x16x32_bf16 v[212:215], v[96:99], v[160:163], v[212:215]
    v_mfma_f32_16x16x32_bf16 v[216:219], v[96:99], v[164:167], v[216:219]
    v_mfma_f32_16x16x32_bf16 v[220:223], v[96:99], v[168:171], v[220:223]
    s_waitcnt lgkmcnt(1)
    v_mfma_f32_16x16x32_bf16 v[224:227], v[100:103], v[156:159], v[224:227]
    v_mfma_f32_16x16x32_bf16 v[228:231], v[100:103], v[160:163], v[228:231]
    v_mfma_f32_16x16x32_bf16 v[232:235], v[100:103], v[164:167], v[232:235]
    v_mfma_f32_16x16x32_bf16 v[236:239], v[100:103], v[168:171], v[236:239]
    s_waitcnt lgkmcnt(0)
    v_mfma_f32_16x16x32_bf16 v[240:243], v[104:107], v[156:159], v[240:243]
    v_mfma_f32_16x16x32_bf16 v[244:247], v[104:107], v[160:163], v[244:247]
    v_mfma_f32_16x16x32_bf16 v[248:251], v[104:107], v[164:167], v[248:251]
    v_mfma_f32_16x16x32_bf16 v[252:255], v[104:107], v[168:171], v[252:255]
    s_lshl_b32 s79, s76, 12
    s_add_u32 s79, s79, s74
    s_add_u32 s76, s76, s78
    s_cmp_ge_u32 s76, 12
    s_cselect_b32 s66, 12, 0
    s_sub_u32 s76, s76, s66
    buffer_load_dwordx4 v[156:159], v4, s[16:19], s79 offen offset:0 sc1
    buffer_load_dwordx4 v[160:163], v4, s[16:19], s79 offen offset:1024 sc1
    buffer_load_dwordx4 v[164:167], v4, s[16:19], s79 offen offset:2048 sc1
    buffer_load_dwordx4 v[168:171], v4, s[16:19], s79 offen offset:3072 sc1
    s_waitcnt vmcnt(27)
    v_mfma_f32_16x16x32_bf16 v[176:179], v[8:11], v[108:111], v[176:179]
    v_mfma_f32_16x16x32_bf16 v[180:183], v[8:11], v[112:115], v[180:183]
    v_mfma_f32_16x16x32_bf16 v[184:187], v[8:11], v[116:119], v[184:187]
    v_mfma_f32_16x16x32_bf16 v[188:191], v[8:11], v[120:123], v[188:191]
    v_mfma_f32_16x16x32_bf16 v[192:195], v[12:15], v[108:111], v[192:195]
    v_mfma_f32_16x16x32_bf16 v[196:199], v[12:15], v[112:115], v[196:199]
    v_mfma_f32_16x16x32_bf16 v[200:203], v[12:15], v[116:119], v[200:203]
    v_mfma_f32_16x16x32_bf16 v[204:207], v[12:15], v[120:123], v[204:207]
    v_mfma_f32_16x16x32_bf16 v[208:211], v[16:19], v[108:111], v[208:211]
    v_mfma_f32_16x16x32_bf16 v[212:215], v[16:19], v[112:115], v[212:215]
    v_mfma_f32_16x16x32_bf16 v[216:219], v[16:19], v[116:119], v[216:219]
    v_mfma_f32_16x16x32_bf16 v[220:223], v[16:19], v[120:123], v[220:223]
    v_mfma_f32_16x16x32_bf16 v[224:227], v[20:23], v[108:111], v[224:227]
    v_mfma_f32_16x16x32_bf16 v[228:231], v[20:23], v[112:115], v[228:231]
    v_mfma_f32_16x16x32_bf16 v[232:235], v[20:23], v[116:119], v[232:235]
    v_mfma_f32_16x16x32_bf16 v[236:239], v[20:23], v[120:123], v[236:239]
    v_mfma_f32_16x16x32_bf16 v[240:243], v[24:27], v[108:111], v[240:243]
    v_mfma_f32_16x16x32_bf16 v[244:247], v[24:27], v[112:115], v[244:247]
    v_mfma_f32_16x16x32_bf16 v[248:251], v[24:27], v[116:119], v[248:251]
    v_mfma_f32_16x16x32_bf16 v[252:255], v[24:27], v[120:123], v[252:255]
    buffer_load_dword v118, v6, s[16:19], 0 offen sc1
    s_lshl_b32 s64, s69, 6
    s_lshl_b32 s65, s60, 4
    s_add_u32 s64, s64, s65
    s_mul_i32 s64, s64, 1280
    s_mul_i32 s65, s70, 160
    s_add_u32 s64, s64, s65
    s_and_b32 s65, s60, 1
    s_mul_i32 s65, s65, 2560
    s_cmp_lt_u32 s60, 2
    s_cselect_b32 s67, 47616, 0
    s_add_u32 s65, s65, s67
    s_add_u32 s65, s65, 91648
    v_add_u32 v120, 0, v0
    v_mul_u32_u24 v121, 6554, v120
    v_lshrrev_b32 v121, 16, v121
    v_mul_u32_u24 v1, 10, v121
    v_sub_u32 v120, v120, v1
    v_mul_u32_u24 v121, 1280, v121
    v_lshl_add_u32 v120, v120, 4, v121
    s_add_u32 m0, s65, 0
    s_nop 0
    buffer_load_dwordx4 v120, s[4:7], s64 offen lds
    v_add_u32 v120, 64, v0
    v_mul_u32_u24 v121, 6554, v120
    v_lshrrev_b32 v121, 16, v121
    v_mul_u32_u24 v1, 10, v121
    v_sub_u32 v120, v120, v1
    v_mul_u32_u24 v121, 1280, v121
    v_lshl_add_u32 v120, v120, 4, v121
    s_add_u32 m0, s65, 1024
    s_nop 0
    buffer_load_dwordx4 v120, s[4:7], s64 offen lds
    v_add_u32 v120, 128, v0
    v_mul_u32_u24 v121, 6554, v120
    v_lshrrev_b32 v121, 16, v121
    v_mul_u32_u24 v1, 10, v121
    v_sub_u32 v120, v120, v1
    v_mul_u32_u24 v121, 1280, v121
    v_lshl_add_u32 v120, v120, 4, v121
    s_add_u32 m0, s65, 2048
    s_mov_b32 exec_hi, 0
    buffer_load_dwordx4 v120, s[4:7], s64 offen lds
    s_mov_b32 exec_hi, -1
    s_waitcnt vmcnt(22)
    v_mfma_f32_16x16x32_bf16 v[176:179], v[28:31], v[124:127], v[176:179]
    v_mfma_f32_16x16x32_bf16 v[180:183], v[28:31], v[128:131], v[180:183]
    v_mfma_f32_16x16x32_bf16 v[184:187], v[28:31], v[132:135], v[184:187]
    v_mfma_f32_16x16x32_bf16 v[188:191], v[28:31], v[136:139], v[188:191]
    v_mfma_f32_16x16x32_bf16 v[192:195], v[32:35], v[124:127], v[192:195]
    v_mfma_f32_16x16x32_bf16 v[196:199], v[32:35], v[128:131], v[196:199]
    v_mfma_f32_16x16x32_bf16 v[200:203], v[32:35], v[132:135], v[200:203]
    v_mfma_f32_16x16x32_bf16 v[204:207], v[32:35], v[136:139], v[204:207]
    v_mfma_f32_16x16x32_bf16 v[208:211], v[36:39], v[124:127], v[208:211]
    v_mfma_f32_16x16x32_bf16 v[212:215], v[36:39], v[128:131], v[212:215]
    v_mfma_f32_16x16x32_bf16 v[216:219], v[36:39], v[132:135], v[216:219]
    v_mfma_f32_16x16x32_bf16 v[220:223], v[36:39], v[136:139], v[220:223]
    v_mfma_f32_16x16x32_bf16 v[224:227], v[40:43], v[124:127], v[224:227]
    v_mfma_f32_16x16x32_bf16 v[228:231], v[40:43], v[128:131], v[228:231]
    v_mfma_f32_16x16x32_bf16 v[232:235], v[40:43], v[132:135], v[232:235]
    v_mfma_f32_16x16x32_bf16 v[236:239], v[40:43], v[136:139], v[236:239]
    v_mfma_f32_16x16x32_bf16 v[240:243], v[44:47], v[124:127], v[240:243]
    v_mfma_f32_16x16x32_bf16 v[244:247], v[44:47], v[128:131], v[244:247]
    v_mfma_f32_16x16x32_bf16 v[248:251], v[44:47], v[132:135], v[248:251]
    v_mfma_f32_16x16x32_bf16 v[252:255], v[44:47], v[136:139], v[252:255]
    s_waitcnt vmcnt(13)
    v_mfma_f32_16x16x32_bf16 v[176:179], v[48:51], v[140:143], v[176:179]
    v_mfma_f32_16x16x32_bf16 v[180:183], v[48:51], v[144:147], v[180:183]
    v_mfma_f32_16x16x32_bf16 v[184:187], v[48:51], v[148:151], v[184:187]
    v_mfma_f32_16x16x32_bf16 v[188:191], v[48:51], v[152:155], v[188:191]
    v_mfma_f32_16x16x32_bf16 v[192:195], v[52:55], v[140:143], v[192:195]
    v_mfma_f32_16x16x32_bf16 v[196:199], v[52:55], v[144:147], v[196:199]
    v_mfma_f32_16x16x32_bf16 v[200:203], v[52:55], v[148:151], v[200:203]
    v_mfma_f32_16x16x32_bf16 v[204:207], v[52:55], v[152:155], v[204:207]
    v_mfma_f32_16x16x32_bf16 v[208:211], v[56:59], v[140:143], v[208:211]
    v_mfma_f32_16x16x32_bf16 v[212:215], v[56:59], v[144:147], v[212:215]
    v_mfma_f32_16x16x32_bf16 v[216:219], v[56:59], v[148:151], v[216:219]
    v_mfma_f32_16x16x32_bf16 v[220:223], v[56:59], v[152:155], v[220:223]
    v_mfma_f32_16x16x32_bf16 v[224:227], v[60:63], v[140:143], v[224:227]
    v_mfma_f32_16x16x32_bf16 v[228:231], v[60:63], v[144:147], v[228:231]
    v_mfma_f32_16x16x32_bf16 v[232:235], v[60:63], v[148:151], v[232:235]
    v_mfma_f32_16x16x32_bf16 v[236:239], v[60:63], v[152:155], v[236:239]
    v_mfma_f32_16x16x32_bf16 v[240:243], v[64:67], v[140:143], v[240:243]
    v_mfma_f32_16x16x32_bf16 v[244:247], v[64:67], v[144:147], v[244:247]
    v_mfma_f32_16x16x32_bf16 v[248:251], v[64:67], v[148:151], v[248:251]
    v_mfma_f32_16x16x32_bf16 v[252:255], v[64:67], v[152:155], v[252:255]
    s_waitcnt vmcnt(4)
    v_mfma_f32_16x16x32_bf16 v[176:179], v[68:71], v[156:159], v[176:179]
    v_mfma_f32_16x16x32_bf16 v[180:183], v[68:71], v[160:163], v[180:183]
    v_mfma_f32_16x16x32_bf16 v[184:187], v[68:71], v[164:167], v[184:187]
    v_mfma_f32_16x16x32_bf16 v[188:191], v[68:71], v[168:171], v[188:191]
    v_mfma_f32_16x16x32_bf16 v[192:195], v[72:75], v[156:159], v[192:195]
    v_mfma_f32_16x16x32_bf16 v[196:199], v[72:75], v[160:163], v[196:199]
    v_mfma_f32_16x16x32_bf16 v[200:203], v[72:75], v[164:167], v[200:203]
    v_mfma_f32_16x16x32_bf16 v[204:207], v[72:75], v[168:171], v[204:207]
    s_nop 1
    ds_write_b128 v174, v[176:179] offset:0
    ds_write_b128 v174, v[180:183] offset:1024
    ds_write_b128 v174, v[184:187] offset:2048
    ds_write_b128 v174, v[188:191] offset:3072
    v_mfma_f32_16x16x32_bf16 v[208:211], v[76:79], v[156:159], v[208:211]
    v_mfma_f32_16x16x32_bf16 v[212:215], v[76:79], v[160:163], v[212:215]
    v_mfma_f32_16x16x32_bf16 v[216:219], v[76:79], v[164:167], v[216:219]
    v_mfma_f32_16x16x32_bf16 v[220:223], v[76:79], v[168:171], v[220:223]
    ds_write_b128 v174, v[192:195] offset:4096
    ds_write_b128 v174, v[196:199] offset:5120
    ds_write_b128 v174, v[200:203] offset:6144
    ds_write_b128 v174, v[204:207] offset:7168
    v_mfma_f32_16x16x32_bf16 v[224:227], v[80:83], v[156:159], v[224:227]
    v_mfma_f32_16x16x32_bf16 v[228:231], v[80:83], v[160:163], v[228:231]
    v_mfma_f32_16x16x32_bf16 v[232:235], v[80:83], v[164:167], v[232:235]
    v_mfma_f32_16x16x32_bf16 v[236:239], v[80:83], v[168:171], v[236:239]
    ds_write_b128 v174, v[208:211] offset:8192
    ds_write_b128 v174, v[212:215] offset:9216
    ds_write_b128 v172, v[216:219] offset:0
    ds_write_b128 v172, v[220:223] offset:1024
    v_mfma_f32_16x16x32_bf16 v[240:243], v[84:87], v[156:159], v[240:243]
    v_mfma_f32_16x16x32_bf16 v[244:247], v[84:87], v[160:163], v[244:247]
    v_mfma_f32_16x16x32_bf16 v[248:251], v[84:87], v[164:167], v[248:251]
    v_mfma_f32_16x16x32_bf16 v[252:255], v[84:87], v[168:171], v[252:255]
    ds_write_b128 v172, v[224:227] offset:2048
    ds_write_b128 v172, v[228:231] offset:3072
    ds_write_b128 v172, v[232:235] offset:4096
    ds_write_b128 v172, v[236:239] offset:5120
    s_lshl_b32 s66, s60, 10
    v_add_u32 v88, s66, v4
    v_add_u32 v89, 98304, v88
    s_mov_b32 s66, 106496
    s_cmp_lt_u32 s60, 2
    s_cselect_b32 s66, s66, 4294965248
    v_add_u32 v90, s66, v88
    ds_write_b128 v172, v[240:243] offset:6144
    ds_write_b128 v172, v[244:247] offset:7168
    ds_write_b128 v172, v[248:251] offset:8192
    ds_write_b128 v172, v[252:255] offset:9216
    v_lshrrev_b32 v2, 2, v0
    v_bfe_u32 v1, v2, 1, 2
    v_xor_b32 v1, s60, v1
    v_lshlrev_b32 v1, 5, v1
    v_lshl_add_u32 v2, v2, 7, v1
    v_and_b32 v1, 3, v0
    v_lshl_add_u32 v2, v1, 3, v2
    v_add_u32 v2, 147456, v2
    v_bfe_u32 v91, v0, 4, 1
    v_mul_u32_u24 v91, 24, v91
    v_add_u32 v91, v91, v3
    v_and_b32 v124, 15, v0
    v_mul_u32_u24 v124, 160, v124
    v_lshrrev_b32 v125, 4, v0
    v_lshl_add_u32 v124, v125, 3, v124
    v_add_u32 v124, s65, v124
    s_waitcnt vmcnt(0)
    v_sub_f32 v119, 1.0, v118
    ds_read_b64 v[108:109], v124 offset:0
    ds_read_b64 v[110:111], v124 offset:32
    ds_read_b64 v[112:113], v124 offset:64
    ds_read_b64 v[114:115], v124 offset:96
    ds_read_b64 v[116:117], v124 offset:128
    s_waitcnt lgkmcnt(0)
    s_barrier
    ds_read_b64_tr_b16 v[92:93], v2 offset:0
    ds_read_b64_tr_b16 v[94:95], v2 offset:2048
    ds_read_b64_tr_b16 v[96:97], v2 offset:4096
    ds_read_b64_tr_b16 v[98:99], v2 offset:6144
    ds_read_b64_tr_b16 v[100:101], v2 offset:8192
    ds_read_b128 v[8:11], v89 offset:0
    ds_read_b128 v[12:15], v89 offset:4096
    ds_read_b128 v[16:19], v90 offset:0
    ds_read_b128 v[20:23], v88 offset:2048
    ds_read_b128 v[24:27], v88 offset:6144
    ds_read_b128 v[28:31], v89 offset:10240
    ds_read_b128 v[32:35], v89 offset:14336
    ds_read_b128 v[36:39], v90 offset:10240
    ds_read_b128 v[40:43], v88 offset:12288
    ds_read_b128 v[44:47], v88 offset:16384
    ds_read_b128 v[48:51], v89 offset:20480
    ds_read_b128 v[52:55], v89 offset:24576
    ds_read_b128 v[56:59], v90 offset:20480
    ds_read_b128 v[60:63], v88 offset:22528
    ds_read_b128 v[64:67], v88 offset:26624
    ds_read_b128 v[68:71], v89 offset:30720
    ds_read_b128 v[72:75], v89 offset:34816
    ds_read_b128 v[76:79], v90 offset:30720
    ds_read_b128 v[80:83], v88 offset:32768
    ds_read_b128 v[84:87], v88 offset:36864
    s_waitcnt lgkmcnt(15)
    v_lshlrev_b32 v124, 16, v108
    v_and_b32 v125, 0xffff0000, v108
    v_lshlrev_b32 v126, 16, v92
    v_and_b32 v127, 0xffff0000, v92
    v_mul_f32 v124, v124, v126
    v_mul_f32 v125, v125, v127
    v_mul_f32 v132, v118, v124
    v_mul_f32 v133, v118, v125
    v_lshlrev_b32 v124, 16, v109
    v_and_b32 v125, 0xffff0000, v109
    v_lshlrev_b32 v126, 16, v93
    v_and_b32 v127, 0xffff0000, v93
    v_mul_f32 v124, v124, v126
    v_mul_f32 v125, v125, v127
    v_mul_f32 v134, v118, v124
    v_mul_f32 v135, v118, v125
    v_lshlrev_b32 v124, 16, v110
    v_and_b32 v125, 0xffff0000, v110
    v_lshlrev_b32 v126, 16, v94
    v_and_b32 v127, 0xffff0000, v94
    v_mul_f32 v124, v124, v126
    v_mul_f32 v125, v125, v127
    v_mul_f32 v136, v118, v124
    v_mul_f32 v137, v118, v125
    v_lshlrev_b32 v124, 16, v111
    v_and_b32 v125, 0xffff0000, v111
    v_lshlrev_b32 v126, 16, v95
    v_and_b32 v127, 0xffff0000, v95
    v_mul_f32 v124, v124, v126
    v_mul_f32 v125, v125, v127
    v_mul_f32 v138, v118, v124
    v_mul_f32 v139, v118, v125
    v_lshlrev_b32 v124, 16, v112
    v_and_b32 v125, 0xffff0000, v112
    v_lshlrev_b32 v126, 16, v96
    v_and_b32 v127, 0xffff0000, v96
    v_mul_f32 v124, v124, v126
    v_mul_f32 v125, v125, v127
    v_mul_f32 v140, v118, v124
    v_mul_f32 v141, v118, v125
    v_lshlrev_b32 v124, 16, v113
    v_and_b32 v125, 0xffff0000, v113
    v_lshlrev_b32 v126, 16, v97
    v_and_b32 v127, 0xffff0000, v97
    v_mul_f32 v124, v124, v126
    v_mul_f32 v125, v125, v127
    v_mul_f32 v142, v118, v124
    v_mul_f32 v143, v118, v125
    v_lshlrev_b32 v124, 16, v114
    v_and_b32 v125, 0xffff0000, v114
    v_lshlrev_b32 v126, 16, v98
    v_and_b32 v127, 0xffff0000, v98
    v_mul_f32 v124, v124, v126
    v_mul_f32 v125, v125, v127
    v_mul_f32 v144, v118, v124
    v_mul_f32 v145, v118, v125
    v_lshlrev_b32 v124, 16, v115
    v_and_b32 v125, 0xffff0000, v115
    v_lshlrev_b32 v126, 16, v99
    v_and_b32 v127, 0xffff0000, v99
    v_mul_f32 v124, v124, v126
    v_mul_f32 v125, v125, v127
    v_mul_f32 v146, v118, v124
    v_mul_f32 v147, v118, v125
    v_lshlrev_b32 v124, 16, v116
    v_and_b32 v125, 0xffff0000, v116
    v_lshlrev_b32 v126, 16, v100
    v_and_b32 v127, 0xffff0000, v100
    v_mul_f32 v124, v124, v126
    v_mul_f32 v125, v125, v127
    v_mul_f32 v148, v118, v124
    v_mul_f32 v149, v118, v125
    v_lshlrev_b32 v124, 16, v117
    v_and_b32 v125, 0xffff0000, v117
    v_lshlrev_b32 v126, 16, v101
    v_and_b32 v127, 0xffff0000, v101
    v_mul_f32 v124, v124, v126
    v_mul_f32 v125, v125, v127
    v_mul_f32 v150, v118, v124
    v_mul_f32 v151, v118, v125
    s_waitcnt lgkmcnt(10)
    v_add_f32 v8, v8, v28
    v_add_f32 v9, v9, v29
    v_add_f32 v10, v10, v30
    v_add_f32 v11, v11, v31
    v_add_f32 v12, v12, v32
    v_add_f32 v13, v13, v33
    v_add_f32 v14, v14, v34
    v_add_f32 v15, v15, v35
    v_add_f32 v16, v16, v36
    v_add_f32 v17, v17, v37
    v_add_f32 v18, v18, v38
    v_add_f32 v19, v19, v39
    v_add_f32 v20, v20, v40
    v_add_f32 v21, v21, v41
    v_add_f32 v22, v22, v42
    v_add_f32 v23, v23, v43
    v_add_f32 v24, v24, v44
    v_add_f32 v25, v25, v45
    v_add_f32 v26, v26, v46
    v_add_f32 v27, v27, v47
    s_waitcnt lgkmcnt(5)
    v_add_f32 v8, v8, v48
    v_add_f32 v9, v9, v49
    v_add_f32 v10, v10, v50
    v_add_f32 v11, v11, v51
    v_add_f32 v12, v12, v52
    v_add_f32 v13, v13, v53
    v_add_f32 v14, v14, v54
    v_add_f32 v15, v15, v55
    v_add_f32 v16, v16, v56
    v_add_f32 v17, v17, v57
    v_add_f32 v18, v18, v58
    v_add_f32 v19, v19, v59
    v_add_f32 v20, v20, v60
    v_add_f32 v21, v21, v61
    v_add_f32 v22, v22, v62
    v_add_f32 v23, v23, v63
    v_add_f32 v24, v24, v64
    v_add_f32 v25, v25, v65
    v_add_f32 v26, v26, v66
    v_add_f32 v27, v27, v67
    s_waitcnt lgkmcnt(0)
    v_add_f32 v8, v8, v68
    v_add_f32 v9, v9, v69
    v_add_f32 v10, v10, v70
    v_add_f32 v11, v11, v71
    v_add_f32 v12, v12, v72
    v_add_f32 v13, v13, v73
    v_add_f32 v14, v14, v74
    v_add_f32 v15, v15, v75
    v_add_f32 v16, v16, v76
    v_add_f32 v17, v17, v77
    v_add_f32 v18, v18, v78
    v_add_f32 v19, v19, v79
    v_add_f32 v20, v20, v80
    v_add_f32 v21, v21, v81
    v_add_f32 v22, v22, v82
    v_add_f32 v23, v23, v83
    v_add_f32 v24, v24, v84
    v_add_f32 v25, v25, v85
    v_add_f32 v26, v26, v86
    v_add_f32 v27, v27, v87
    v_fma_f32 v132, v119, v8, v132
    v_fma_f32 v133, v119, v9, v133
    v_fma_f32 v134, v119, v10, v134
    v_fma_f32 v135, v119, v11, v135
    v_cvt_pk_bf16_f32 v152, v132, v133
    v_cvt_pk_bf16_f32 v153, v134, v135
    v_fma_f32 v136, v119, v12, v136
    v_fma_f32 v137, v119, v13, v137
    v_fma_f32 v138, v119, v14, v138
    v_fma_f32 v139, v119, v15, v139
    v_cvt_pk_bf16_f32 v154, v136, v137
    v_cvt_pk_bf16_f32 v155, v138, v139
    s_nop 1
    v_permlane16_swap_b32 v152, v154
    v_permlane16_swap_b32 v153, v155
    buffer_store_dwordx4 v[152:155], v91, s[20:23], 0 offen offset:0 nt
    v_fma_f32 v140, v119, v16, v140
    v_fma_f32 v141, v119, v17, v141
    v_fma_f32 v142, v119, v18, v142
    v_fma_f32 v143, v119, v19, v143
    v_cvt_pk_bf16_f32 v156, v140, v141
    v_cvt_pk_bf16_f32 v157, v142, v143
    v_fma_f32 v144, v119, v20, v144
    v_fma_f32 v145, v119, v21, v145
    v_fma_f32 v146, v119, v22, v146
    v_fma_f32 v147, v119, v23, v147
    v_cvt_pk_bf16_f32 v158, v144, v145
    v_cvt_pk_bf16_f32 v159, v146, v147
    s_nop 1
    v_permlane16_swap_b32 v156, v158
    v_permlane16_swap_b32 v157, v159
    buffer_store_dwordx4 v[156:159], v91, s[20:23], 0 offen offset:64 nt
    v_fma_f32 v148, v119, v24, v148
    v_fma_f32 v149, v119, v25, v149
    v_fma_f32 v150, v119, v26, v150
    v_fma_f32 v151, v119, v27, v151
    v_cvt_pk_bf16_f32 v160, v148, v149
    v_cvt_pk_bf16_f32 v161, v150, v151
    buffer_store_dwordx2 v[160:161], v3, s[20:23], 0 offen offset:128 nt
    s_endpgm
L_loader:
    s_sub_u32 s66, s60, 4
    v_lshrrev_b32 v3, 3, v0
    s_lshl_b32 s67, s66, 5
    s_lshl_b32 s68, s62, 7
    s_add_u32 s67, s67, s68
    v_bfe_u32 v4, v3, 1, 3
    v_and_b32 v5, 7, v0
    v_xor_b32 v4, v4, v5
    v_add_u32 v3, s67, v3
    v_mul_u32_u24 v3, 1280, v3
    v_lshl_add_u32 v200, v4, 4, v3
    v_xor_b32 v4, 4, v4
    v_lshl_add_u32 v201, v4, 4, v3
    v_add_u32 v201, 10240, v201
    v_add_u32 v202, 20480, v200
    v_add_u32 v203, 20480, v201
    v_bfe_u32 v3, v0, 2, 2
    s_lshl_b32 s67, s66, 4
    v_add_u32 v3, s67, v3
    v_mul_u32_u24 v3, 3072, v3
    v_lshrrev_b32 v4, 4, v0
    v_lshl_add_u32 v3, v4, 6, v3
    v_and_b32 v4, 3, v0
    v_lshl_add_u32 v3, v4, 4, v3
    s_lshl_b32 s67, s63, 8
    v_add_u32 v204, s67, v3
    v_add_u32 v205, 12288, v204
    v_xor_b32 v206, 32, v204
    v_add_u32 v206, 24576, v206
    v_add_u32 v207, 12288, v206
    s_add_u32 s68, s62, s63
    s_mul_i32 s69, s68, 6554
    s_lshr_b32 s69, s69, 16
    s_mul_i32 s69, s69, 10
    s_sub_u32 s68, s68, s69
    s_and_b32 s68, s68, 14
    s_lshl_b32 s69, s66, 12
    s_mov_b32 s71, 0
    s_waitcnt lgkmcnt(0)
    s_load_dword s61, s[58:59], 0
    s_mov_b32 s4, s32
    s_and_b32 s5, s33, 0xffff
    s_mov_b32 s6, 2621440
    s_mov_b32 s7, 0x20000
    s_mov_b32 s8, s46
    s_and_b32 s9, s47, 0xffff
    s_mov_b32 s10, 1966080
    s_mov_b32 s11, 0x20000
    s_mov_b32 s12, s48
    s_and_b32 s13, s49, 0xffff
    s_mov_b32 s14, 1966080
    s_mov_b32 s15, 0x20000
    s_lshl_b32 s72, s68, 7
    s_mul_i32 s73, s68, 196608
    s_add_u32 s74, s71, s69
    s_add_u32 m0, s74, 0
    s_add_u32 s68, s68, 1
    buffer_load_dwordx4 v200, s[4:7], s72 offen lds
    s_add_u32 m0, s74, 1024
    s_nop 0
    buffer_load_dwordx4 v201, s[4:7], s72 offen lds
    s_add_u32 m0, s74, 2048
    s_nop 0
    buffer_load_dwordx4 v202, s[4:7], s72 offen lds
    s_add_u32 m0, s74, 3072
    s_nop 0
    buffer_load_dwordx4 v203, s[4:7], s72 offen lds
    s_add_u32 m0, s74, 16384
    s_nop 0
    buffer_load_dwordx4 v204, s[8:11], s73 offen lds
    s_add_u32 m0, s74, 32768
    s_nop 0
    buffer_load_dwordx4 v204, s[12:15], s73 offen lds
    s_add_u32 m0, s74, 17408
    s_nop 0
    buffer_load_dwordx4 v205, s[8:11], s73 offen lds
    s_add_u32 m0, s74, 33792
    s_nop 0
    buffer_load_dwordx4 v205, s[12:15], s73 offen lds
    s_add_u32 m0, s74, 18432
    s_nop 0
    buffer_load_dwordx4 v206, s[8:11], s73 offen lds
    s_add_u32 m0, s74, 34816
    s_nop 0
    buffer_load_dwordx4 v206, s[12:15], s73 offen lds
    s_add_u32 m0, s74, 19456
    s_nop 0
    buffer_load_dwordx4 v207, s[8:11], s73 offen lds
    s_add_u32 m0, s74, 35840
    s_nop 0
    buffer_load_dwordx4 v207, s[12:15], s73 offen lds
    s_cmp_ge_u32 s68, 10
    s_cselect_b32 s68, 0, s68
    s_add_u32 s71, s71, 49152
    s_cmp_eq_u32 s71, 147456
    s_cselect_b32 s71, 0, s71
    s_mov_b32 s16, s58
    s_and_b32 s17, s59, 0xffff
    s_mov_b32 s18, 14680064
    s_mov_b32 s19, 0x20000
    v_lshlrev_b32 v15, 7, v0
    v_add_u32 v16, 12288, v15
    v_add_u32 v17, 20480, v15
    v_add_u32 v18, 28672, v15
    v_add_u32 v19, 36864, v15
    v_add_u32 v15, 4096, v15
    v_lshl_add_u32 v3, v0, 2, 0
    v_add_u32 v3, 157696, v3
    v_mov_b32 v4, 0
    ds_write_b32 v3, v4
    v_mov_b32 v196, 157696
    v_mov_b32 v199, 1
    s_waitcnt lgkmcnt(0)
    s_mul_i32 s61, s61, 1664525
    s_add_u32 s61, s61, 1013904223
    s_lshl_b32 s72, s68, 7
    s_mul_i32 s73, s68, 196608
    s_add_u32 s74, s71, s69
    s_add_u32 m0, s74, 0
    s_add_u32 s68, s68, 1
    buffer_load_dwordx4 v200, s[4:7], s72 offen lds
    s_add_u32 m0, s74, 1024
    s_nop 0
    buffer_load_dwordx4 v201, s[4:7], s72 offen lds
    s_add_u32 m0, s74, 2048
    s_nop 0
    buffer_load_dwordx4 v202, s[4:7], s72 offen lds
    s_add_u32 m0, s74, 3072
    s_nop 0
    buffer_load_dwordx4 v203, s[4:7], s72 offen lds
    s_add_u32 m0, s74, 16384
    s_nop 0
    buffer_load_dwordx4 v204, s[8:11], s73 offen lds
    s_add_u32 m0, s74, 32768
    s_nop 0
    buffer_load_dwordx4 v204, s[12:15], s73 offen lds
    s_add_u32 m0, s74, 17408
    s_nop 0
    buffer_load_dwordx4 v205, s[8:11], s73 offen lds
    s_add_u32 m0, s74, 33792
    s_nop 0
    buffer_load_dwordx4 v205, s[12:15], s73 offen lds
    s_add_u32 m0, s74, 18432
    s_nop 0
    buffer_load_dwordx4 v206, s[8:11], s73 offen lds
    s_add_u32 m0, s74, 34816
    s_nop 0
    buffer_load_dwordx4 v206, s[12:15], s73 offen lds
    s_add_u32 m0, s74, 19456
    s_nop 0
    buffer_load_dwordx4 v207, s[8:11], s73 offen lds
    s_add_u32 m0, s74, 35840
    s_nop 0
    buffer_load_dwordx4 v207, s[12:15], s73 offen lds
    s_cmp_ge_u32 s68, 10
    s_cselect_b32 s68, 0, s68
    s_add_u32 s71, s71, 49152
    s_cmp_eq_u32 s71, 147456
    s_cselect_b32 s71, 0, s71
    s_mov_b32 s76, 0
L_ld_loop:
    s_waitcnt vmcnt(12)
    s_barrier
    s_lshl_b32 s72, s68, 7
    s_mul_i32 s73, s68, 196608
    s_add_u32 s74, s71, s69
    s_add_u32 m0, s74, 0
    s_add_u32 s68, s68, 1
    buffer_load_dwordx4 v200, s[4:7], s72 offen lds
    s_add_u32 m0, s74, 1024
    s_nop 0
    buffer_load_dwordx4 v201, s[4:7], s72 offen lds
    s_add_u32 m0, s74, 2048
    s_nop 0
    buffer_load_dwordx4 v202, s[4:7], s72 offen lds
    s_add_u32 m0, s74, 3072
    s_nop 0
    buffer_load_dwordx4 v203, s[4:7], s72 offen lds
    s_add_u32 m0, s74, 16384
    s_nop 0
    buffer_load_dwordx4 v204, s[8:11], s73 offen lds
    s_add_u32 m0, s74, 32768
    s_nop 0
    buffer_load_dwordx4 v204, s[12:15], s73 offen lds
    s_add_u32 m0, s74, 17408
    s_nop 0
    buffer_load_dwordx4 v205, s[8:11], s73 offen lds
    s_add_u32 m0, s74, 33792
    s_nop 0
    buffer_load_dwordx4 v205, s[12:15], s73 offen lds
    s_add_u32 m0, s74, 18432
    s_nop 0
    buffer_load_dwordx4 v206, s[8:11], s73 offen lds
    s_add_u32 m0, s74, 34816
    s_nop 0
    buffer_load_dwordx4 v206, s[12:15], s73 offen lds
    s_add_u32 m0, s74, 19456
    s_nop 0
    buffer_load_dwordx4 v207, s[8:11], s73 offen lds
    s_add_u32 m0, s74, 35840
    s_nop 0
    buffer_load_dwordx4 v207, s[12:15], s73 offen lds
    s_cmp_ge_u32 s68, 10
    s_cselect_b32 s68, 0, s68
    s_add_u32 s71, s71, 49152
    s_cmp_eq_u32 s71, 147456
    s_cselect_b32 s71, 0, s71
    s_add_u32 s76, s76, 1
    s_cmp_lt_u32 s76, 8
    s_cbranch_scc1 L_ld_loop
    s_and_b32 s64, s2, 7
    s_lshl_b32 s64, s64, 7
    s_add_u32 s64, s64, 2048
    v_mov_b32 v15, s64
    s_cmp_lg_u32 s66, 2
    s_cbranch_scc1 L_b8n
    v_min_u32 v16, 63, v0
    v_and_b32 v197, 1, v16
    v_lshrrev_b32 v16, 1, v16
    v_lshlrev_b32 v16, 7, v16
    v_lshl_add_u32 v16, v197, 4, v16
    v_add_u32 v16, 4096, v16
    buffer_load_dwordx4 v[224:227], v16, s[16:19], 0 offen sc1
    buffer_load_dword v222, v15, s[16:19], 0 offen sc1
    s_waitcnt vmcnt(14)
    s_branch L_b8
L_b8n:
    s_waitcnt vmcnt(12)
L_b8:
    s_barrier
    s_cmp_ge_u32 s66, 2
    s_cbranch_scc1 L_ld67
    s_and_b32 s67, s2, 7
    s_mul_i32 s67, s67, 24
    s_lshr_b32 s68, s2, 3
    s_add_u32 s67, s67, s68
    s_lshl_b32 s67, s67, 1
    s_add_u32 s67, s67, s66
    s_mul_i32 s68, s66, 21248
    s_add_u32 s68, s68, 49152
    s_mov_b32 s20, s40
    s_and_b32 s21, s41, 0xffff
    s_mov_b32 s22, 2621440
    s_mov_b32 s23, 0x20000
    s_mov_b32 s24, s42
    s_and_b32 s25, s43, 0xffff
    s_mov_b32 s26, 1280
    s_mov_b32 s27, 0x20000
    s_lshl_b32 s69, s67, 12
    s_add_u32 s70, s68, 16640
    v_lshlrev_b32 v10, 4, v0
    s_add_u32 s71, s69, 0
    s_add_u32 m0, s68, 32
    s_nop 0
    buffer_load_dwordx4 v10, s[20:23], s71 offen offset:0 nt lds
    buffer_load_dwordx4 v10, s[20:23], s71 offen offset:1024 nt lds
    buffer_load_dwordx4 v10, s[20:23], s71 offen offset:2048 nt lds
    buffer_load_dwordx4 v10, s[20:23], s71 offen offset:3072 nt lds
    s_add_u32 s71, s69, 4
    s_add_u32 m0, s68, 8352
    s_nop 0
    buffer_load_dwordx4 v10, s[20:23], s71 offen offset:0 nt lds
    buffer_load_dwordx4 v10, s[20:23], s71 offen offset:1024 nt lds
    buffer_load_dwordx4 v10, s[20:23], s71 offen offset:2048 nt lds
    buffer_load_dwordx4 v10, s[20:23], s71 offen offset:3072 nt lds
    v_lshrrev_b32 v1, 4, v0
    v_and_b32 v2, 15, v0
    v_add3_u32 v3, v1, v2, -16
    v_lshlrev_b32 v4, 1, v3
    v_add_u32 v4, s69, v4
    v_cmp_gt_i32 vcc, 0, v3
    s_lshl_b32 s71, s67, 1
    v_mov_b32 v7, s71
    v_cndmask_b32 v4, v4, -1, vcc
    buffer_load_ushort v5, v4, s[20:23], 0 offen
    buffer_load_ushort v7, v7, s[24:27], 0 offen
    v_mul_u32_u24 v8, 4160, v1
    v_add_u32 v8, s68, v8
    v_lshl_add_u32 v9, v2, 1, v8
    v_add_u32 v11, s68, v10
    v_mov_b32 v12, 0
    v_mov_b32 v13, 0
    v_lshl_add_u32 v14, v0, 3, s70
    ds_write_b64 v14, v[12:13] offset:4096
    v_add_u32 v3, 1, v2
    v_and_b32 v4, 3, v3
    v_sub_u32 v3, v3, v4
    v_lshl_add_u32 v3, v1, 3, v3
    v_mul_u32_u24 v4, 4160, v4
    v_lshl_add_u32 v20, v3, 1, v4
    v_add_u32 v20, s68, v20
    v_lshlrev_b32 v3, 4, v1
    v_lshlrev_b32 v4, 5, v2
    v_sub_u32 v3, v3, v4
    v_add_u32 v3, 480, v3
    v_add_u32 v21, s70, v3
    v_mov_b32 v32, 0
    v_mov_b32 v33, 0
    v_mov_b32 v34, 0
    v_mov_b32 v35, 0
    v_mov_b32 v36, 0
    v_mov_b32 v37, 0
    v_mov_b32 v38, 0
    v_mov_b32 v39, 0
    v_mov_b32 v40, 0
    v_mov_b32 v41, 0
    v_mov_b32 v42, 0
    v_mov_b32 v43, 0
    v_mov_b32 v44, 0
    v_mov_b32 v45, 0
    v_mov_b32 v46, 0
    v_mov_b32 v47, 0
    v_mov_b32 v48, 0
    v_mov_b32 v49, 0
    v_mov_b32 v50, 0
    v_mov_b32 v51, 0
    v_mov_b32 v52, 0
    v_mov_b32 v53, 0
    v_mov_b32 v54, 0
    v_mov_b32 v55, 0
    v_mov_b32 v56, 0
    v_mov_b32 v57, 0
    v_mov_b32 v58, 0
    v_mov_b32 v59, 0
    v_mov_b32 v60, 0
    v_mov_b32 v61, 0
    v_mov_b32 v62, 0
    v_mov_b32 v63, 0
    s_waitcnt vmcnt(10)
    ds_read_b32 v197, v196 offset:12
    s_waitcnt lgkmcnt(0)
    v_readfirstlane_b32 s57, v197
    s_nop 0
    s_cmp_eq_u32 s57, 0
    s_cbranch_scc1 L_cv_l
    s_add_u32 s71, s69, 1048576
    s_mov_b32 m0, s70
    s_nop 0
    buffer_load_dwordx4 v10, s[16:19], s71 offen offset:0 sc1 lds
    buffer_load_dwordx4 v10, s[16:19], s71 offen offset:1024 sc1 lds
    buffer_load_dwordx4 v10, s[16:19], s71 offen offset:2048 sc1 lds
    buffer_load_dwordx4 v10, s[16:19], s71 offen offset:3072 sc1 lds
    s_barrier
    s_branch L_cv_b
L_cv_l:
    s_barrier
    s_mov_b32 s56, 0
L_lw_7:
    ds_read_b32 v197, v196 offset:12
    s_add_u32 s56, s56, 1
    s_waitcnt lgkmcnt(0)
    v_readfirstlane_b32 s57, v197
    s_cmp_ge_u32 s56, 0x100000
    s_cselect_b32 s57, 1, s57
    s_cmp_ge_u32 s57, 1
    s_cbranch_scc1 L_lwd_8
    s_sleep 1
    s_branch L_lw_7
L_lwd_8:
    s_add_u32 s71, s69, 1048576
    s_mov_b32 m0, s70
    s_nop 0
    buffer_load_dwordx4 v10, s[16:19], s71 offen offset:0 sc1 lds
    buffer_load_dwordx4 v10, s[16:19], s71 offen offset:1024 sc1 lds
    buffer_load_dwordx4 v10, s[16:19], s71 offen offset:2048 sc1 lds
    buffer_load_dwordx4 v10, s[16:19], s71 offen offset:3072 sc1 lds
L_cv_b:
    s_waitcnt vmcnt(4)
    ds_read_b128 v[64:67], v11 offset:32
    ds_read_b128 v[68:71], v11 offset:8352
    ds_read_b64 v[74:75], v11 offset:48
    ds_read_b128 v[80:83], v11 offset:1056
    ds_read_b128 v[84:87], v11 offset:9376
    ds_read_b64 v[90:91], v11 offset:1072
    ds_read_b128 v[96:99], v11 offset:2080
    ds_read_b128 v[100:103], v11 offset:10400
    ds_read_b64 v[106:107], v11 offset:2096
    ds_read_b128 v[112:115], v11 offset:3104
    ds_read_b128 v[116:119], v11 offset:11424
    ds_read_b64 v[122:123], v11 offset:3120
    ds_write_b16 v9, v5
    v_lshlrev_b32 v7, 16, v7
    s_waitcnt lgkmcnt(10)
    v_alignbit_b32 v76, v68, v64, 16
    v_alignbit_b32 v77, v69, v65, 16
    v_alignbit_b32 v78, v70, v66, 16
    v_alignbit_b32 v79, v71, v67, 16
    v_alignbit_b32 v68, v66, v68, 16
    v_alignbit_b32 v69, v67, v69, 16
    v_alignbit_b32 v70, v74, v70, 16
    v_alignbit_b32 v71, v75, v71, 16
    ds_write_b128 v11, v[76:79] offset:4192
    ds_write_b128 v11, v[68:71] offset:12512
    s_waitcnt lgkmcnt(9)
    v_alignbit_b32 v92, v84, v80, 16
    v_alignbit_b32 v93, v85, v81, 16
    v_alignbit_b32 v94, v86, v82, 16
    v_alignbit_b32 v95, v87, v83, 16
    v_alignbit_b32 v84, v82, v84, 16
    v_alignbit_b32 v85, v83, v85, 16
    v_alignbit_b32 v86, v90, v86, 16
    v_alignbit_b32 v87, v91, v87, 16
    ds_write_b128 v11, v[92:95] offset:5216
    ds_write_b128 v11, v[84:87] offset:13536
    s_waitcnt lgkmcnt(8)
    v_alignbit_b32 v108, v100, v96, 16
    v_alignbit_b32 v109, v101, v97, 16
    v_alignbit_b32 v110, v102, v98, 16
    v_alignbit_b32 v111, v103, v99, 16
    v_alignbit_b32 v100, v98, v100, 16
    v_alignbit_b32 v101, v99, v101, 16
    v_alignbit_b32 v102, v106, v102, 16
    v_alignbit_b32 v103, v107, v103, 16
    ds_write_b128 v11, v[108:111] offset:6240
    ds_write_b128 v11, v[100:103] offset:14560
    s_waitcnt lgkmcnt(7)
    v_alignbit_b32 v124, v116, v112, 16
    v_alignbit_b32 v125, v117, v113, 16
    v_alignbit_b32 v126, v118, v114, 16
    v_alignbit_b32 v127, v119, v115, 16
    v_alignbit_b32 v116, v114, v116, 16
    v_alignbit_b32 v117, v115, v117, 16
    v_alignbit_b32 v118, v122, v118, 16
    v_alignbit_b32 v119, v123, v119, 16
    ds_write_b128 v11, v[124:127] offset:7264
    ds_write_b128 v11, v[116:119] offset:15584
    s_mov_b32 s74, 4
    s_mov_b32 s75, 0
    s_lshl_b32 s72, s66, 2
    v_add_u32 v198, s72, v196
    s_waitcnt vmcnt(0) lgkmcnt(0)
    s_mov_b64 exec, 1
    ds_add_u32 v198, v199 offset:32
    s_mov_b64 exec, -1
L_conv_main:
    s_waitcnt vmcnt(0)
    s_setprio 1
    ds_read_b64 v[64:65], v20 offset:0
    ds_read_b64 v[66:67], v20 offset:8
    ds_read_b128 v[96:99], v21 offset:3584
    ds_read_b128 v[100:103], v21 offset:3072
    ds_read_b128 v[104:107], v21 offset:2560
    ds_read_b128 v[108:111], v21 offset:2048
    ds_read_b128 v[112:115], v21 offset:1536
    ds_read_b128 v[116:119], v21 offset:1024
    ds_read_b128 v[120:123], v21 offset:512
    ds_read_b128 v[124:127], v21 offset:0
    ds_read_b64 v[68:69], v20 offset:512
    ds_read_b64 v[70:71], v20 offset:520
    ds_read_b64 v[72:73], v20 offset:1024
    ds_read_b64 v[74:75], v20 offset:1032
    ds_read_b64 v[76:77], v20 offset:1536
    ds_read_b64 v[78:79], v20 offset:1544
    ds_read_b64 v[80:81], v20 offset:2048
    ds_read_b64 v[82:83], v20 offset:2056
    ds_read_b64 v[84:85], v20 offset:2560
    ds_read_b64 v[86:87], v20 offset:2568
    ds_read_b64 v[88:89], v20 offset:3072
    ds_read_b64 v[90:91], v20 offset:3080
    ds_read_b64 v[92:93], v20 offset:3584
    ds_read_b64 v[94:95], v20 offset:3592
    s_mov_b32 s71, 0
    .p2align 3
L_conv_loop:
    v_add_u32 v20, 64, v20
    v_add_u32 v21, 64, v21
    s_waitcnt lgkmcnt(15)
    v_mfma_f32_16x16x32_bf16 v[32:35], v[64:67], v[96:99], v[32:35]
    s_waitcnt lgkmcnt(15)
    v_mfma_f32_16x16x32_bf16 v[36:39], v[64:67], v[100:103], v[36:39]
    s_waitcnt lgkmcnt(15)
    v_mfma_f32_16x16x32_bf16 v[40:43], v[64:67], v[104:107], v[40:43]
    s_waitcnt lgkmcnt(15)
    v_mfma_f32_16x16x32_bf16 v[44:47], v[64:67], v[108:111], v[44:47]
    s_waitcnt lgkmcnt(15)
    v_mfma_f32_16x16x32_bf16 v[48:51], v[64:67], v[112:115], v[48:51]
    s_waitcnt lgkmcnt(15)
    v_mfma_f32_16x16x32_bf16 v[52:55], v[64:67], v[116:119], v[52:55]
    s_waitcnt lgkmcnt(15)
    v_mfma_f32_16x16x32_bf16 v[56:59], v[64:67], v[120:123], v[56:59]
    s_waitcnt lgkmcnt(14)
    v_mfma_f32_16x16x32_bf16 v[60:63], v[64:67], v[124:127], v[60:63]
    s_waitcnt lgkmcnt(12)
    v_mfma_f32_16x16x32_bf16 v[36:39], v[68:71], v[96:99], v[36:39]
    ds_read_b64 v[128:129], v20 offset:0
    v_mfma_f32_16x16x32_bf16 v[40:43], v[68:71], v[100:103], v[40:43]
    ds_read_b64 v[130:131], v20 offset:8
    v_mfma_f32_16x16x32_bf16 v[44:47], v[68:71], v[104:107], v[44:47]
    ds_read_b128 v[160:163], v21 offset:3584
    v_mfma_f32_16x16x32_bf16 v[48:51], v[68:71], v[108:111], v[48:51]
    ds_read_b128 v[164:167], v21 offset:3072
    v_mfma_f32_16x16x32_bf16 v[52:55], v[68:71], v[112:115], v[52:55]
    ds_read_b128 v[168:171], v21 offset:2560
    v_mfma_f32_16x16x32_bf16 v[56:59], v[68:71], v[116:119], v[56:59]
    ds_read_b128 v[172:175], v21 offset:2048
    v_mfma_f32_16x16x32_bf16 v[60:63], v[68:71], v[120:123], v[60:63]
    ds_read_b128 v[176:179], v21 offset:1536
    s_waitcnt lgkmcnt(15)
    v_mfma_f32_16x16x32_bf16 v[40:43], v[72:75], v[96:99], v[40:43]
    ds_read_b128 v[180:183], v21 offset:1024
    v_mfma_f32_16x16x32_bf16 v[44:47], v[72:75], v[100:103], v[44:47]
    ds_read_b128 v[184:187], v21 offset:512
    v_mfma_f32_16x16x32_bf16 v[48:51], v[72:75], v[104:107], v[48:51]
    ds_read_b128 v[188:191], v21 offset:0
    v_mfma_f32_16x16x32_bf16 v[52:55], v[72:75], v[108:111], v[52:55]
    ds_read_b64 v[132:133], v20 offset:512
    v_mfma_f32_16x16x32_bf16 v[56:59], v[72:75], v[112:115], v[56:59]
    ds_read_b64 v[134:135], v20 offset:520
    v_mfma_f32_16x16x32_bf16 v[60:63], v[72:75], v[116:119], v[60:63]
    ds_read_b64 v[136:137], v20 offset:1024
    s_waitcnt lgkmcnt(15)
    v_mfma_f32_16x16x32_bf16 v[44:47], v[76:79], v[96:99], v[44:47]
    ds_read_b64 v[138:139], v20 offset:1032
    v_mfma_f32_16x16x32_bf16 v[48:51], v[76:79], v[100:103], v[48:51]
    ds_read_b64 v[140:141], v20 offset:1536
    v_mfma_f32_16x16x32_bf16 v[52:55], v[76:79], v[104:107], v[52:55]
    ds_read_b64 v[142:143], v20 offset:1544
    v_mfma_f32_16x16x32_bf16 v[56:59], v[76:79], v[108:111], v[56:59]
    ds_read_b64 v[144:145], v20 offset:2048
    v_mfma_f32_16x16x32_bf16 v[60:63], v[76:79], v[112:115], v[60:63]
    ds_read_b64 v[146:147], v20 offset:2056
    s_waitcnt lgkmcnt(15)
    v_mfma_f32_16x16x32_bf16 v[48:51], v[80:83], v[96:99], v[48:51]
    ds_read_b64 v[148:149], v20 offset:2560
    v_mfma_f32_16x16x32_bf16 v[52:55], v[80:83], v[100:103], v[52:55]
    ds_read_b64 v[150:151], v20 offset:2568
    v_mfma_f32_16x16x32_bf16 v[56:59], v[80:83], v[104:107], v[56:59]
    ds_read_b64 v[152:153], v20 offset:3072
    v_mfma_f32_16x16x32_bf16 v[60:63], v[80:83], v[108:111], v[60:63]
    ds_read_b64 v[154:155], v20 offset:3080
    s_waitcnt lgkmcnt(15)
    v_mfma_f32_16x16x32_bf16 v[52:55], v[84:87], v[96:99], v[52:55]
    ds_read_b64 v[156:157], v20 offset:3584
    v_mfma_f32_16x16x32_bf16 v[56:59], v[84:87], v[100:103], v[56:59]
    ds_read_b64 v[158:159], v20 offset:3592
    v_mfma_f32_16x16x32_bf16 v[60:63], v[84:87], v[104:107], v[60:63]
    s_waitcnt lgkmcnt(15)
    v_mfma_f32_16x16x32_bf16 v[56:59], v[88:91], v[96:99], v[56:59]
    v_mfma_f32_16x16x32_bf16 v[60:63], v[88:91], v[100:103], v[60:63]
    s_waitcnt lgkmcnt(15)
    v_mfma_f32_16x16x32_bf16 v[60:63], v[92:95], v[96:99], v[60:63]
    v_add_u32 v20, 64, v20
    v_add_u32 v21, 64, v21
    s_waitcnt lgkmcnt(15)
    v_mfma_f32_16x16x32_bf16 v[32:35], v[128:131], v[160:163], v[32:35]
    s_waitcnt lgkmcnt(15)
    v_mfma_f32_16x16x32_bf16 v[36:39], v[128:131], v[164:167], v[36:39]
    s_waitcnt lgkmcnt(15)
    v_mfma_f32_16x16x32_bf16 v[40:43], v[128:131], v[168:171], v[40:43]
    s_waitcnt lgkmcnt(15)
    v_mfma_f32_16x16x32_bf16 v[44:47], v[128:131], v[172:175], v[44:47]
    s_waitcnt lgkmcnt(15)
    v_mfma_f32_16x16x32_bf16 v[48:51], v[128:131], v[176:179], v[48:51]
    s_waitcnt lgkmcnt(15)
    v_mfma_f32_16x16x32_bf16 v[52:55], v[128:131], v[180:183], v[52:55]
    s_waitcnt lgkmcnt(15)
    v_mfma_f32_16x16x32_bf16 v[56:59], v[128:131], v[184:187], v[56:59]
    s_waitcnt lgkmcnt(14)
    v_mfma_f32_16x16x32_bf16 v[60:63], v[128:131], v[188:191], v[60:63]
    s_waitcnt lgkmcnt(12)
    v_mfma_f32_16x16x32_bf16 v[36:39], v[132:135], v[160:163], v[36:39]
    ds_read_b64 v[64:65], v20 offset:0
    v_mfma_f32_16x16x32_bf16 v[40:43], v[132:135], v[164:167], v[40:43]
    ds_read_b64 v[66:67], v20 offset:8
    v_mfma_f32_16x16x32_bf16 v[44:47], v[132:135], v[168:171], v[44:47]
    ds_read_b128 v[96:99], v21 offset:3584
    v_mfma_f32_16x16x32_bf16 v[48:51], v[132:135], v[172:175], v[48:51]
    ds_read_b128 v[100:103], v21 offset:3072
    v_mfma_f32_16x16x32_bf16 v[52:55], v[132:135], v[176:179], v[52:55]
    ds_read_b128 v[104:107], v21 offset:2560
    v_mfma_f32_16x16x32_bf16 v[56:59], v[132:135], v[180:183], v[56:59]
    ds_read_b128 v[108:111], v21 offset:2048
    v_mfma_f32_16x16x32_bf16 v[60:63], v[132:135], v[184:187], v[60:63]
    ds_read_b128 v[112:115], v21 offset:1536
    s_waitcnt lgkmcnt(15)
    v_mfma_f32_16x16x32_bf16 v[40:43], v[136:139], v[160:163], v[40:43]
    ds_read_b128 v[116:119], v21 offset:1024
    v_mfma_f32_16x16x32_bf16 v[44:47], v[136:139], v[164:167], v[44:47]
    ds_read_b128 v[120:123], v21 offset:512
    v_mfma_f32_16x16x32_bf16 v[48:51], v[136:139], v[168:171], v[48:51]
    ds_read_b128 v[124:127], v21 offset:0
    v_mfma_f32_16x16x32_bf16 v[52:55], v[136:139], v[172:175], v[52:55]
    ds_read_b64 v[68:69], v20 offset:512
    v_mfma_f32_16x16x32_bf16 v[56:59], v[136:139], v[176:179], v[56:59]
    ds_read_b64 v[70:71], v20 offset:520
    v_mfma_f32_16x16x32_bf16 v[60:63], v[136:139], v[180:183], v[60:63]
    ds_read_b64 v[72:73], v20 offset:1024
    s_waitcnt lgkmcnt(15)
    v_mfma_f32_16x16x32_bf16 v[44:47], v[140:143], v[160:163], v[44:47]
    ds_read_b64 v[74:75], v20 offset:1032
    v_mfma_f32_16x16x32_bf16 v[48:51], v[140:143], v[164:167], v[48:51]
    ds_read_b64 v[76:77], v20 offset:1536
    v_mfma_f32_16x16x32_bf16 v[52:55], v[140:143], v[168:171], v[52:55]
    ds_read_b64 v[78:79], v20 offset:1544
    v_mfma_f32_16x16x32_bf16 v[56:59], v[140:143], v[172:175], v[56:59]
    ds_read_b64 v[80:81], v20 offset:2048
    v_mfma_f32_16x16x32_bf16 v[60:63], v[140:143], v[176:179], v[60:63]
    ds_read_b64 v[82:83], v20 offset:2056
    s_waitcnt lgkmcnt(15)
    v_mfma_f32_16x16x32_bf16 v[48:51], v[144:147], v[160:163], v[48:51]
    ds_read_b64 v[84:85], v20 offset:2560
    v_mfma_f32_16x16x32_bf16 v[52:55], v[144:147], v[164:167], v[52:55]
    ds_read_b64 v[86:87], v20 offset:2568
    v_mfma_f32_16x16x32_bf16 v[56:59], v[144:147], v[168:171], v[56:59]
    ds_read_b64 v[88:89], v20 offset:3072
    v_mfma_f32_16x16x32_bf16 v[60:63], v[144:147], v[172:175], v[60:63]
    ds_read_b64 v[90:91], v20 offset:3080
    s_waitcnt lgkmcnt(15)
    v_mfma_f32_16x16x32_bf16 v[52:55], v[148:151], v[160:163], v[52:55]
    ds_read_b64 v[92:93], v20 offset:3584
    v_mfma_f32_16x16x32_bf16 v[56:59], v[148:151], v[164:167], v[56:59]
    ds_read_b64 v[94:95], v20 offset:3592
    v_mfma_f32_16x16x32_bf16 v[60:63], v[148:151], v[168:171], v[60:63]
    s_waitcnt lgkmcnt(15)
    v_mfma_f32_16x16x32_bf16 v[56:59], v[152:155], v[160:163], v[56:59]
    v_mfma_f32_16x16x32_bf16 v[60:63], v[152:155], v[164:167], v[60:63]
    s_waitcnt lgkmcnt(15)
    v_mfma_f32_16x16x32_bf16 v[60:63], v[156:159], v[160:163], v[60:63]
    s_add_u32 s71, s71, 1
    s_cmp_lt_u32 s71, s74
    s_cbranch_scc1 L_conv_loop
    s_cmp_eq_u32 s75, 2
    s_cbranch_scc1 L_help_dump
    s_cmp_eq_u32 s75, 0
    s_cbranch_scc1 L_conv_ep
    s_mov_b32 s56, 0
L_lw_9:
    ds_read_b32 v197, v198 offset:40
    s_add_u32 s56, s56, 1
    s_waitcnt lgkmcnt(0)
    v_readfirstlane_b32 s57, v197
    s_cmp_ge_u32 s56, 0x100000
    s_cselect_b32 s57, 1, s57
    s_cmp_ge_u32 s57, 1
    s_cbranch_scc1 L_lwd_10
    s_sleep 1
    s_branch L_lw_9
L_lwd_10:
    s_mul_i32 s72, s66, 98304
    s_add_u32 s72, s72, 40960
    v_add_u32 v3, s72, v10
    ds_read_b128 v[128:131], v3 offset:0
    ds_read_b128 v[132:135], v3 offset:1024
    ds_read_b128 v[136:139], v3 offset:2048
    ds_read_b128 v[140:143], v3 offset:3072
    ds_read_b128 v[144:147], v3 offset:4096
    ds_read_b128 v[148:151], v3 offset:5120
    ds_read_b128 v[152:155], v3 offset:6144
    ds_read_b128 v[156:159], v3 offset:7168
    s_waitcnt lgkmcnt(7)
    v_add_f32 v32, v32, v128
    v_add_f32 v33, v33, v129
    v_add_f32 v34, v34, v130
    v_add_f32 v35, v35, v131
    s_waitcnt lgkmcnt(6)
    v_add_f32 v36, v36, v132
    v_add_f32 v37, v37, v133
    v_add_f32 v38, v38, v134
    v_add_f32 v39, v39, v135
    s_waitcnt lgkmcnt(5)
    v_add_f32 v40, v40, v136
    v_add_f32 v41, v41, v137
    v_add_f32 v42, v42, v138
    v_add_f32 v43, v43, v139
    s_waitcnt lgkmcnt(4)
    v_add_f32 v44, v44, v140
    v_add_f32 v45, v45, v141
    v_add_f32 v46, v46, v142
    v_add_f32 v47, v47, v143
    s_waitcnt lgkmcnt(3)
    v_add_f32 v48, v48, v144
    v_add_f32 v49, v49, v145
    v_add_f32 v50, v50, v146
    v_add_f32 v51, v51, v147
    s_waitcnt lgkmcnt(2)
    v_add_f32 v52, v52, v148
    v_add_f32 v53, v53, v149
    v_add_f32 v54, v54, v150
    v_add_f32 v55, v55, v151
    s_waitcnt lgkmcnt(1)
    v_add_f32 v56, v56, v152
    v_add_f32 v57, v57, v153
    v_add_f32 v58, v58, v154
    v_add_f32 v59, v59, v155
    s_waitcnt lgkmcnt(0)
    v_add_f32 v60, v60, v156
    v_add_f32 v61, v61, v157
    v_add_f32 v62, v62, v158
    v_add_f32 v63, v63, v159
L_conv_ep:
    s_waitcnt lgkmcnt(0)
    v_lshlrev_b32 v3, 3, v1
    v_lshl_add_u32 v3, v2, 5, v3
    v_sub_u32 v4, 504, v3
    v_add_u32 v4, s70, v4
    v_add_u32 v3, s68, v3
    ds_read_b64 v[64:65], v4 offset:3584
    ds_read_b64 v[66:67], v4 offset:3072
    ds_read_b64 v[68:69], v4 offset:2560
    ds_read_b64 v[70:71], v4 offset:2048
    ds_read_b64 v[72:73], v4 offset:1536
    ds_read_b64 v[74:75], v4 offset:1024
    ds_read_b64 v[76:77], v4 offset:512
    ds_read_b64 v[78:79], v4 offset:0
    s_waitcnt lgkmcnt(7)
    v_and_b32 v96, 0xffff0000, v65
    v_lshlrev_b32 v97, 16, v65
    v_and_b32 v98, 0xffff0000, v64
    v_lshlrev_b32 v99, 16, v64
    v_fma_f32 v32, v96, v7, v32
    v_fma_f32 v33, v97, v7, v33
    v_fma_f32 v34, v98, v7, v34
    v_fma_f32 v35, v99, v7, v35
    v_cvt_pk_bf16_f32 v64, v32, v33
    v_cvt_pk_bf16_f32 v65, v34, v35
    ds_write_b64 v3, v[64:65] offset:0
    s_waitcnt lgkmcnt(7)
    v_and_b32 v100, 0xffff0000, v67
    v_lshlrev_b32 v101, 16, v67
    v_and_b32 v102, 0xffff0000, v66
    v_lshlrev_b32 v103, 16, v66
    v_fma_f32 v36, v100, v7, v36
    v_fma_f32 v37, v101, v7, v37
    v_fma_f32 v38, v102, v7, v38
    v_fma_f32 v39, v103, v7, v39
    v_cvt_pk_bf16_f32 v66, v36, v37
    v_cvt_pk_bf16_f32 v67, v38, v39
    ds_write_b64 v3, v[66:67] offset:512
    s_waitcnt lgkmcnt(7)
    v_and_b32 v104, 0xffff0000, v69
    v_lshlrev_b32 v105, 16, v69
    v_and_b32 v106, 0xffff0000, v68
    v_lshlrev_b32 v107, 16, v68
    v_fma_f32 v40, v104, v7, v40
    v_fma_f32 v41, v105, v7, v41
    v_fma_f32 v42, v106, v7, v42
    v_fma_f32 v43, v107, v7, v43
    v_cvt_pk_bf16_f32 v68, v40, v41
    v_cvt_pk_bf16_f32 v69, v42, v43
    ds_write_b64 v3, v[68:69] offset:1024
    s_waitcnt lgkmcnt(7)
    v_and_b32 v108, 0xffff0000, v71
    v_lshlrev_b32 v109, 16, v71
    v_and_b32 v110, 0xffff0000, v70
    v_lshlrev_b32 v111, 16, v70
    v_fma_f32 v44, v108, v7, v44
    v_fma_f32 v45, v109, v7, v45
    v_fma_f32 v46, v110, v7, v46
    v_fma_f32 v47, v111, v7, v47
    v_cvt_pk_bf16_f32 v70, v44, v45
    v_cvt_pk_bf16_f32 v71, v46, v47
    ds_write_b64 v3, v[70:71] offset:1536
    s_waitcnt lgkmcnt(7)
    v_and_b32 v112, 0xffff0000, v73
    v_lshlrev_b32 v113, 16, v73
    v_and_b32 v114, 0xffff0000, v72
    v_lshlrev_b32 v115, 16, v72
    v_fma_f32 v48, v112, v7, v48
    v_fma_f32 v49, v113, v7, v49
    v_fma_f32 v50, v114, v7, v50
    v_fma_f32 v51, v115, v7, v51
    v_cvt_pk_bf16_f32 v72, v48, v49
    v_cvt_pk_bf16_f32 v73, v50, v51
    ds_write_b64 v3, v[72:73] offset:2048
    s_waitcnt lgkmcnt(7)
    v_and_b32 v116, 0xffff0000, v75
    v_lshlrev_b32 v117, 16, v75
    v_and_b32 v118, 0xffff0000, v74
    v_lshlrev_b32 v119, 16, v74
    v_fma_f32 v52, v116, v7, v52
    v_fma_f32 v53, v117, v7, v53
    v_fma_f32 v54, v118, v7, v54
    v_fma_f32 v55, v119, v7, v55
    v_cvt_pk_bf16_f32 v74, v52, v53
    v_cvt_pk_bf16_f32 v75, v54, v55
    ds_write_b64 v3, v[74:75] offset:2560
    s_waitcnt lgkmcnt(7)
    v_and_b32 v120, 0xffff0000, v77
    v_lshlrev_b32 v121, 16, v77
    v_and_b32 v122, 0xffff0000, v76
    v_lshlrev_b32 v123, 16, v76
    v_fma_f32 v56, v120, v7, v56
    v_fma_f32 v57, v121, v7, v57
    v_fma_f32 v58, v122, v7, v58
    v_fma_f32 v59, v123, v7, v59
    v_cvt_pk_bf16_f32 v76, v56, v57
    v_cvt_pk_bf16_f32 v77, v58, v59
    ds_write_b64 v3, v[76:77] offset:3072
    s_waitcnt lgkmcnt(7)
    v_and_b32 v124, 0xffff0000, v79
    v_lshlrev_b32 v125, 16, v79
    v_and_b32 v126, 0xffff0000, v78
    v_lshlrev_b32 v127, 16, v78
    v_fma_f32 v60, v124, v7, v60
    v_fma_f32 v61, v125, v7, v61
    v_fma_f32 v62, v126, v7, v62
    v_fma_f32 v63, v127, v7, v63
    v_cvt_pk_bf16_f32 v78, v60, v61
    v_cvt_pk_bf16_f32 v79, v62, v63
    ds_write_b64 v3, v[78:79] offset:3584
    s_add_u32 s71, s69, 3670016
    s_waitcnt lgkmcnt(0)
    ds_read_b128 v[96:99], v11 offset:0
    ds_read_b128 v[100:103], v11 offset:1024
    ds_read_b128 v[104:107], v11 offset:2048
    ds_read_b128 v[108:111], v11 offset:3072
    s_waitcnt lgkmcnt(3)
    buffer_store_dwordx4 v[96:99], v10, s[16:19], s71 offen offset:0 sc1
    s_waitcnt lgkmcnt(2)
    buffer_store_dwordx4 v[100:103], v10, s[16:19], s71 offen offset:1024 sc1
    s_waitcnt lgkmcnt(1)
    buffer_store_dwordx4 v[104:107], v10, s[16:19], s71 offen offset:2048 sc1
    s_waitcnt lgkmcnt(0)
    buffer_store_dwordx4 v[108:111], v10, s[16:19], s71 offen offset:3072 sc1
    s_mov_b64 exec, 1
    ds_add_u32 v196, v199 offset:16
    s_mov_b64 exec, -1
    s_lshr_b32 s71, s67, 3
    s_lshl_b32 s71, s71, 7
    s_and_b32 s72, s67, 7
    s_lshl_b32 s72, s72, 2
    s_add_u32 s71, s71, s72
    s_add_u32 s71, s71, 49152
    s_waitcnt vmcnt(0)
    v_mov_b32 v3, s61
    v_mov_b32 v4, 0
    s_mov_b64 exec, 1
    buffer_store_dword v3, v4, s[16:19], s71 offen sc1
    s_mov_b64 exec, -1
    s_setprio 0
    s_cmp_lg_u32 s66, 3
    s_cbranch_scc1 L_join
    s_mov_b32 s56, 0
L_lw_11:
    ds_read_b32 v197, v196 offset:16
    s_add_u32 s56, s56, 1
    s_waitcnt lgkmcnt(0)
    v_readfirstlane_b32 s57, v197
    s_cmp_ge_u32 s56, 0x100000
    s_cselect_b32 s57, 4, s57
    s_cmp_ge_u32 s57, 4
    s_cbranch_scc1 L_lwd_12
    s_sleep 2
    s_branch L_lw_11
L_lwd_12:
    s_mov_b32 s56, 0
L_lw_13:
    ds_read_b32 v197, v196 offset:20
    s_add_u32 s56, s56, 1
    s_waitcnt lgkmcnt(0)
    v_readfirstlane_b32 s57, v197
    s_cmp_ge_u32 s56, 0x100000
    s_cselect_b32 s57, 1, s57
    s_cmp_ge_u32 s57, 1
    s_cbranch_scc1 L_lwd_14
    s_sleep 2
    s_branch L_lw_13
L_lwd_14:
    s_branch L_w7
L_ld67:
    s_waitcnt vmcnt(0)
    s_cmp_eq_u32 s66, 3
    s_cbranch_scc1 L_ld7a
    v_xor_b32 v224, s61, v224
    v_xor_b32 v225, s61, v225
    v_xor_b32 v226, s61, v226
    v_xor_b32 v227, s61, v227
    v_or3_b32 v224, v224, v225, v226
    v_or_b32 v224, v224, v227
    v_cmp_ne_u32 vcc, 0, v224
    s_cmp_eq_u64 vcc, 0
    s_cselect_b32 s72, 1, 0
    s_cbranch_scc0 L_w6a
    s_mov_b64 exec, 1
    ds_add_u32 v196, v199 offset:12
    s_mov_b64 exec, -1
L_w6a:
    v_cmp_ne_u32 vcc, s61, v222
    s_cmp_eq_u64 vcc, 0
    s_cselect_b32 s73, 1, 0
    s_cbranch_scc0 L_w6b
    s_mov_b64 exec, 1
    ds_add_u32 v196, v199 offset:20
    s_mov_b64 exec, -1
L_w6b:
    s_barrier
    s_cmp_eq_u32 s72, 1
    s_cbranch_scc1 L_w6c
    s_mov_b32 s64, 0
L_poll_15:
    buffer_load_dwordx4 v[224:227], v16, s[16:19], 0 offen sc1
    s_waitcnt vmcnt(0)
    v_xor_b32 v224, s61, v224
    v_xor_b32 v225, s61, v225
    v_xor_b32 v226, s61, v226
    v_xor_b32 v227, s61, v227
    v_or3_b32 v224, v224, v225, v226
    v_or_b32 v224, v224, v227
    v_cmp_ne_u32 vcc, 0, v224
    s_add_u32 s64, s64, 1
    s_cmp_eq_u64 vcc, 0
    s_cbranch_scc1 L_pdone_16
    s_sleep 2
    s_cmp_lt_u32 s64, 0x8000
    s_cbranch_scc1 L_poll_15
L_pdone_16:
    s_mov_b64 exec, 1
    ds_add_u32 v196, v199 offset:12
    s_mov_b64 exec, -1
L_w6c:
    s_cmp_eq_u32 s73, 1
    s_cbranch_scc1 L_w6e
    s_mov_b32 s64, 0
L_poll_17:
    buffer_load_dword v20, v15, s[16:19], 0 offen sc1
    s_waitcnt vmcnt(0)
    v_xor_b32 v20, s61, v20
    v_cmp_ne_u32 vcc, 0, v20
    s_add_u32 s64, s64, 1
    s_cmp_eq_u64 vcc, 0
    s_cbranch_scc1 L_pdone_18
    s_sleep 2
    s_cmp_lt_u32 s64, 0x8000
    s_cbranch_scc1 L_poll_17
L_pdone_18:
    s_mov_b64 exec, 1
    ds_add_u32 v196, v199 offset:20
    s_mov_b64 exec, -1
    s_branch L_w6e
L_ld7a:
    s_barrier
    s_branch L_ld7
L_w6e:
    s_cmp_lg_u32 s2, 0
    s_cbranch_scc1 L_help
    s_mov_b32 s71, 0
    v_mov_b32 v3, s61
    v_mov_b32 v4, 0
    s_mov_b64 exec, 1
    buffer_store_dword v3, v4, s[16:19], s71 offen sc1
    s_mov_b64 exec, -1
L_help:
    s_branch L_join
    s_mov_b32 s76, 0
    s_mov_b32 s74, 1
    s_mov_b32 s75, 2
    v_lshrrev_b32 v1, 4, v0
    v_and_b32 v2, 15, v0
    v_lshlrev_b32 v10, 4, v0
    v_add_u32 v3, 1, v2
    v_and_b32 v4, 3, v3
    v_sub_u32 v3, v3, v4
    v_lshl_add_u32 v3, v1, 3, v3
    v_mul_u32_u24 v4, 4160, v4
    v_lshl_add_u32 v22, v3, 1, v4
    v_add_u32 v22, 49536, v22
    v_lshlrev_b32 v3, 4, v1
    v_lshlrev_b32 v4, 5, v2
    v_sub_u32 v3, v3, v4
    v_add_u32 v23, 66656, v3
    v_mov_b32 v198, v196
    v_add_u32 v24, 40960, v10
L_help_next:
    v_mov_b32 v20, v22
    v_mov_b32 v21, v23
    v_mov_b32 v32, 0
    v_mov_b32 v33, 0
    v_mov_b32 v34, 0
    v_mov_b32 v35, 0
    v_mov_b32 v36, 0
    v_mov_b32 v37, 0
    v_mov_b32 v38, 0
    v_mov_b32 v39, 0
    v_mov_b32 v40, 0
    v_mov_b32 v41, 0
    v_mov_b32 v42, 0
    v_mov_b32 v43, 0
    v_mov_b32 v44, 0
    v_mov_b32 v45, 0
    v_mov_b32 v46, 0
    v_mov_b32 v47, 0
    v_mov_b32 v48, 0
    v_mov_b32 v49, 0
    v_mov_b32 v50, 0
    v_mov_b32 v51, 0
    v_mov_b32 v52, 0
    v_mov_b32 v53, 0
    v_mov_b32 v54, 0
    v_mov_b32 v55, 0
    v_mov_b32 v56, 0
    v_mov_b32 v57, 0
    v_mov_b32 v58, 0
    v_mov_b32 v59, 0
    v_mov_b32 v60, 0
    v_mov_b32 v61, 0
    v_mov_b32 v62, 0
    v_mov_b32 v63, 0
    s_mov_b32 s56, 0
L_lw_19:
    ds_read_b32 v197, v198 offset:32
    s_add_u32 s56, s56, 1
    s_waitcnt lgkmcnt(0)
    v_readfirstlane_b32 s57, v197
    s_cmp_ge_u32 s56, 0x100000
    s_cselect_b32 s57, 1, s57
    s_cmp_ge_u32 s57, 1
    s_cbranch_scc1 L_lwd_20
    s_sleep 1
    s_branch L_lw_19
L_lwd_20:
    s_branch L_conv_main
L_help_dump:
    s_mov_b32 s56, 0
L_lw_21:
    ds_read_b32 v197, v196 offset:4
    s_add_u32 s56, s56, 1
    s_waitcnt lgkmcnt(0)
    v_readfirstlane_b32 s57, v197
    s_cmp_ge_u32 s56, 0x100000
    s_cselect_b32 s57, 4, s57
    s_cmp_ge_u32 s57, 4
    s_cbranch_scc1 L_lwd_22
    s_sleep 1
    s_branch L_lw_21
L_lwd_22:
    ds_write_b128 v24, v[32:35] offset:0
    ds_write_b128 v24, v[36:39] offset:1024
    ds_write_b128 v24, v[40:43] offset:2048
    ds_write_b128 v24, v[44:47] offset:3072
    ds_write_b128 v24, v[48:51] offset:4096
    ds_write_b128 v24, v[52:55] offset:5120
    ds_write_b128 v24, v[56:59] offset:6144
    ds_write_b128 v24, v[60:63] offset:7168
    s_waitcnt lgkmcnt(0)
    s_mov_b64 exec, 1
    ds_add_u32 v198, v199 offset:40
    s_mov_b64 exec, -1
    v_add_u32 v198, 4, v198
    v_add_u32 v22, 21248, v22
    v_add_u32 v23, 21248, v23
    v_add_u32 v24, 98304, v24
    s_add_u32 s76, s76, 1
    s_cmp_lt_u32 s76, 2
    s_cbranch_scc1 L_help_next
    s_setprio 0
    s_branch L_join
L_ld7:
    s_mov_b32 s3, 1
    s_branch L_w7b
L_w7:
    s_mov_b32 s3, 0
L_w7b:
    s_and_b32 s67, s2, 1
    s_lshl_b32 s67, s67, 4
    s_and_b32 s64, s2, 2
    s_lshl_b32 s64, s64, 2
    s_add_u32 s67, s67, s64
    s_bfe_u32 s64, s2, 0x30003
    s_add_u32 s67, s67, s64
    s_and_b32 s68, s2, 4
    s_lshr_b32 s79, s2, 6
    s_add_u32 s68, s68, s79
    s_lshl_b32 s79, s79, 1
    s_add_u32 s64, s64, s79
    s_mov_b32 s78, 0
    s_mov_b32 s79, 1
    v_lshlrev_b32 v10, 4, v0
    v_add_u32 v11, 4096, v10
    s_mul_i32 s75, s68, 245760
    s_add_u32 s75, s75, 12582912
    s_add_u32 s78, s78, s79
    s_cmp_ge_u32 s78, 12
    s_cselect_b32 s64, 12, 0
    s_sub_u32 s78, s78, s64
    s_add_u32 s78, s78, s79
    s_cmp_ge_u32 s78, 12
    s_cselect_b32 s64, 12, 0
    s_sub_u32 s78, s78, s64
    s_add_u32 s78, s78, s79
    s_cmp_ge_u32 s78, 12
    s_cselect_b32 s64, 12, 0
    s_sub_u32 s78, s78, s64
    s_add_u32 s78, s78, s79
    s_cmp_ge_u32 s78, 12
    s_cselect_b32 s64, 12, 0
    s_sub_u32 s78, s78, s64
    s_mul_i32 s68, s68, 80
    s_lshl_b32 s69, s68, 4
    v_min_u32 v12, 19, v0
    v_and_b32 v197, 1, v12
    v_lshrrev_b32 v12, 1, v12
    v_lshlrev_b32 v12, 7, v12
    v_lshl_add_u32 v12, v197, 4, v12
    v_add_u32 v12, 49152, v12
    v_add_u32 v12, s69, v12
    v_lshrrev_b32 v3, 3, v0
    v_and_b32 v4, 7, v0
    v_lshlrev_b32 v5, 4, v4
    v_lshl_add_u32 v5, v3, 12, v5
    v_and_b32 v6, 6, v3
    v_xor_b32 v6, v6, v4
    v_lshlrev_b32 v6, 4, v6
    v_lshl_add_u32 v6, v3, 7, v6
    v_add_u32 v6, 147456, v6
    s_lshl_b32 s69, s68, 12
    s_lshl_b32 s70, s67, 7
    s_add_u32 s69, s69, s70
    s_add_u32 s69, s69, 3670016
    s_cmp_eq_u32 s3, 0
    s_cbranch_scc1 L_w7c
    s_mov_b32 s56, 0
L_lw_23:
    ds_read_b32 v197, v196 offset:20
    s_add_u32 s56, s56, 1
    s_waitcnt lgkmcnt(0)
    v_readfirstlane_b32 s57, v197
    s_cmp_ge_u32 s56, 0x100000
    s_cselect_b32 s57, 1, s57
    s_cmp_ge_u32 s57, 1
    s_cbranch_scc1 L_lwd_24
    s_sleep 1
    s_branch L_lw_23
L_lwd_24:
L_w7c:
    s_mul_i32 s72, s78, 5120
    s_add_u32 s72, s72, s75
    s_add_u32 s78, s78, s79
    s_cmp_ge_u32 s78, 12
    s_cselect_b32 s64, 12, 0
    s_sub_u32 s78, s78, s64
    s_mov_b32 m0, 98304
    s_nop 0
    buffer_load_dwordx4 v10, s[16:19], s72 offen offset:0 sc1 lds
    buffer_load_dwordx4 v10, s[16:19], s72 offen offset:1024 sc1 lds
    buffer_load_dwordx4 v10, s[16:19], s72 offen offset:2048 sc1 lds
    buffer_load_dwordx4 v10, s[16:19], s72 offen offset:3072 sc1 lds
    s_mov_b32 m0, 102400
    s_nop 0
    buffer_load_dwordx4 v11, s[16:19], s72 offen sc1 lds
    s_add_u32 s72, s72, 61440
    s_mov_b32 m0, 108544
    s_nop 0
    buffer_load_dwordx4 v10, s[16:19], s72 offen offset:0 sc1 lds
    buffer_load_dwordx4 v10, s[16:19], s72 offen offset:1024 sc1 lds
    buffer_load_dwordx4 v10, s[16:19], s72 offen offset:2048 sc1 lds
    buffer_load_dwordx4 v10, s[16:19], s72 offen offset:3072 sc1 lds
    s_mov_b32 m0, 112640
    s_nop 0
    buffer_load_dwordx4 v11, s[16:19], s72 offen sc1 lds
    s_add_u32 s72, s72, 61440
    s_mov_b32 m0, 118784
    s_nop 0
    buffer_load_dwordx4 v10, s[16:19], s72 offen offset:0 sc1 lds
    buffer_load_dwordx4 v10, s[16:19], s72 offen offset:1024 sc1 lds
    buffer_load_dwordx4 v10, s[16:19], s72 offen offset:2048 sc1 lds
    buffer_load_dwordx4 v10, s[16:19], s72 offen offset:3072 sc1 lds
    s_mov_b32 m0, 122880
    s_nop 0
    buffer_load_dwordx4 v11, s[16:19], s72 offen sc1 lds
    s_add_u32 s72, s72, 61440
    s_mov_b32 m0, 129024
    s_nop 0
    buffer_load_dwordx4 v10, s[16:19], s72 offen offset:0 sc1 lds
    buffer_load_dwordx4 v10, s[16:19], s72 offen offset:1024 sc1 lds
    buffer_load_dwordx4 v10, s[16:19], s72 offen offset:2048 sc1 lds
    buffer_load_dwordx4 v10, s[16:19], s72 offen offset:3072 sc1 lds
    s_mov_b32 m0, 133120
    s_nop 0
    buffer_load_dwordx4 v11, s[16:19], s72 offen sc1 lds
    s_mul_i32 s72, s78, 5120
    s_add_u32 s72, s72, s75
    s_add_u32 s78, s78, s79
    s_cmp_ge_u32 s78, 12
    s_cselect_b32 s64, 12, 0
    s_sub_u32 s78, s78, s64
    s_mov_b32 m0, 103424
    s_nop 0
    buffer_load_dwordx4 v10, s[16:19], s72 offen offset:0 sc1 lds
    buffer_load_dwordx4 v10, s[16:19], s72 offen offset:1024 sc1 lds
    buffer_load_dwordx4 v10, s[16:19], s72 offen offset:2048 sc1 lds
    buffer_load_dwordx4 v10, s[16:19], s72 offen offset:3072 sc1 lds
    s_mov_b32 m0, 107520
    s_nop 0
    buffer_load_dwordx4 v11, s[16:19], s72 offen sc1 lds
    s_add_u32 s72, s72, 61440
    s_mov_b32 m0, 113664
    s_nop 0
    buffer_load_dwordx4 v10, s[16:19], s72 offen offset:0 sc1 lds
    buffer_load_dwordx4 v10, s[16:19], s72 offen offset:1024 sc1 lds
    buffer_load_dwordx4 v10, s[16:19], s72 offen offset:2048 sc1 lds
    buffer_load_dwordx4 v10, s[16:19], s72 offen offset:3072 sc1 lds
    s_mov_b32 m0, 117760
    s_nop 0
    buffer_load_dwordx4 v11, s[16:19], s72 offen sc1 lds
    s_add_u32 s72, s72, 61440
    s_mov_b32 m0, 123904
    s_nop 0
    buffer_load_dwordx4 v10, s[16:19], s72 offen offset:0 sc1 lds
    buffer_load_dwordx4 v10, s[16:19], s72 offen offset:1024 sc1 lds
    buffer_load_dwordx4 v10, s[16:19], s72 offen offset:2048 sc1 lds
    buffer_load_dwordx4 v10, s[16:19], s72 offen offset:3072 sc1 lds
    s_mov_b32 m0, 128000
    s_nop 0
    buffer_load_dwordx4 v11, s[16:19], s72 offen sc1 lds
    s_add_u32 s72, s72, 61440
    s_mov_b32 m0, 134144
    s_nop 0
    buffer_load_dwordx4 v10, s[16:19], s72 offen offset:0 sc1 lds
    buffer_load_dwordx4 v10, s[16:19], s72 offen offset:1024 sc1 lds
    buffer_load_dwordx4 v10, s[16:19], s72 offen offset:2048 sc1 lds
    buffer_load_dwordx4 v10, s[16:19], s72 offen offset:3072 sc1 lds
    s_mov_b32 m0, 138240
    s_nop 0
    buffer_load_dwordx4 v11, s[16:19], s72 offen sc1 lds
    s_mov_b32 s56, 0
L_lw_25:
    ds_read_b32 v197, v196 offset:4
    s_add_u32 s56, s56, 1
    s_waitcnt lgkmcnt(0)
    v_readfirstlane_b32 s57, v197
    s_cmp_ge_u32 s56, 0x100000
    s_cselect_b32 s57, 4, s57
    s_cmp_ge_u32 s57, 4
    s_cbranch_scc1 L_lwd_26
    s_sleep 2
    s_branch L_lw_25
L_lwd_26:
    s_mul_i32 s72, s78, 5120
    s_add_u32 s72, s72, s75
    s_add_u32 s78, s78, s79
    s_cmp_ge_u32 s78, 12
    s_cselect_b32 s64, 12, 0
    s_sub_u32 s78, s78, s64
    s_mov_b32 m0, 0
    s_nop 0
    buffer_load_dwordx4 v10, s[16:19], s72 offen offset:0 sc1 lds
    buffer_load_dwordx4 v10, s[16:19], s72 offen offset:1024 sc1 lds
    buffer_load_dwordx4 v10, s[16:19], s72 offen offset:2048 sc1 lds
    buffer_load_dwordx4 v10, s[16:19], s72 offen offset:3072 sc1 lds
    s_mov_b32 m0, 4096
    s_nop 0
    buffer_load_dwordx4 v11, s[16:19], s72 offen sc1 lds
    s_add_u32 s72, s72, 61440
    s_mov_b32 m0, 10240
    s_nop 0
    buffer_load_dwordx4 v10, s[16:19], s72 offen offset:0 sc1 lds
    buffer_load_dwordx4 v10, s[16:19], s72 offen offset:1024 sc1 lds
    buffer_load_dwordx4 v10, s[16:19], s72 offen offset:2048 sc1 lds
    buffer_load_dwordx4 v10, s[16:19], s72 offen offset:3072 sc1 lds
    s_mov_b32 m0, 14336
    s_nop 0
    buffer_load_dwordx4 v11, s[16:19], s72 offen sc1 lds
    s_add_u32 s72, s72, 61440
    s_mov_b32 m0, 20480
    s_nop 0
    buffer_load_dwordx4 v10, s[16:19], s72 offen offset:0 sc1 lds
    buffer_load_dwordx4 v10, s[16:19], s72 offen offset:1024 sc1 lds
    buffer_load_dwordx4 v10, s[16:19], s72 offen offset:2048 sc1 lds
    buffer_load_dwordx4 v10, s[16:19], s72 offen offset:3072 sc1 lds
    s_mov_b32 m0, 24576
    s_nop 0
    buffer_load_dwordx4 v11, s[16:19], s72 offen sc1 lds
    s_add_u32 s72, s72, 61440
    s_mov_b32 m0, 30720
    s_nop 0
    buffer_load_dwordx4 v10, s[16:19], s72 offen offset:0 sc1 lds
    buffer_load_dwordx4 v10, s[16:19], s72 offen offset:1024 sc1 lds
    buffer_load_dwordx4 v10, s[16:19], s72 offen offset:2048 sc1 lds
    buffer_load_dwordx4 v10, s[16:19], s72 offen offset:3072 sc1 lds
    s_mov_b32 m0, 34816
    s_nop 0
    buffer_load_dwordx4 v11, s[16:19], s72 offen sc1 lds
    s_mul_i32 s72, s78, 5120
    s_add_u32 s72, s72, s75
    s_add_u32 s78, s78, s79
    s_cmp_ge_u32 s78, 12
    s_cselect_b32 s64, 12, 0
    s_sub_u32 s78, s78, s64
    s_mov_b32 m0, 5120
    s_nop 0
    buffer_load_dwordx4 v10, s[16:19], s72 offen offset:0 sc1 lds
    buffer_load_dwordx4 v10, s[16:19], s72 offen offset:1024 sc1 lds
    buffer_load_dwordx4 v10, s[16:19], s72 offen offset:2048 sc1 lds
    buffer_load_dwordx4 v10, s[16:19], s72 offen offset:3072 sc1 lds
    s_mov_b32 m0, 9216
    s_nop 0
    buffer_load_dwordx4 v11, s[16:19], s72 offen sc1 lds
    s_add_u32 s72, s72, 61440
    s_mov_b32 m0, 15360
    s_nop 0
    buffer_load_dwordx4 v10, s[16:19], s72 offen offset:0 sc1 lds
    buffer_load_dwordx4 v10, s[16:19], s72 offen offset:1024 sc1 lds
    buffer_load_dwordx4 v10, s[16:19], s72 offen offset:2048 sc1 lds
    buffer_load_dwordx4 v10, s[16:19], s72 offen offset:3072 sc1 lds
    s_mov_b32 m0, 19456
    s_nop 0
    buffer_load_dwordx4 v11, s[16:19], s72 offen sc1 lds
    s_add_u32 s72, s72, 61440
    s_mov_b32 m0, 25600
    s_nop 0
    buffer_load_dwordx4 v10, s[16:19], s72 offen offset:0 sc1 lds
    buffer_load_dwordx4 v10, s[16:19], s72 offen offset:1024 sc1 lds
    buffer_load_dwordx4 v10, s[16:19], s72 offen offset:2048 sc1 lds
    buffer_load_dwordx4 v10, s[16:19], s72 offen offset:3072 sc1 lds
    s_mov_b32 m0, 29696
    s_nop 0
    buffer_load_dwordx4 v11, s[16:19], s72 offen sc1 lds
    s_add_u32 s72, s72, 61440
    s_mov_b32 m0, 35840
    s_nop 0
    buffer_load_dwordx4 v10, s[16:19], s72 offen offset:0 sc1 lds
    buffer_load_dwordx4 v10, s[16:19], s72 offen offset:1024 sc1 lds
    buffer_load_dwordx4 v10, s[16:19], s72 offen offset:2048 sc1 lds
    buffer_load_dwordx4 v10, s[16:19], s72 offen offset:3072 sc1 lds
    s_mov_b32 m0, 39936
    s_nop 0
    buffer_load_dwordx4 v11, s[16:19], s72 offen sc1 lds
    s_waitcnt vmcnt(40)
    s_mov_b64 exec, 1
    ds_add_u32 v196, v199 offset:0
    s_mov_b64 exec, -1
    s_waitcnt vmcnt(0)
    s_mov_b64 exec, 1
    ds_add_u32 v196, v199 offset:0
    s_mov_b64 exec, -1
    s_mov_b32 s56, 0
L_lw_27:
    ds_read_b32 v197, v196 offset:4
    s_add_u32 s56, s56, 1
    s_waitcnt lgkmcnt(0)
    v_readfirstlane_b32 s57, v197
    s_cmp_ge_u32 s56, 0x100000
    s_cselect_b32 s57, 12, s57
    s_cmp_ge_u32 s57, 12
    s_cbranch_scc1 L_lwd_28
    s_sleep 4
    s_branch L_lw_27
L_lwd_28:
    s_mov_b32 s64, 0
L_poll_29:
    buffer_load_dwordx4 v[16:19], v12, s[16:19], 0 offen sc1
    s_waitcnt vmcnt(0)
    v_xor_b32 v16, s61, v16
    v_xor_b32 v17, s61, v17
    v_xor_b32 v18, s61, v18
    v_xor_b32 v19, s61, v19
    v_or3_b32 v16, v16, v17, v18
    v_or_b32 v16, v16, v19
    v_cmp_ne_u32 vcc, 0, v16
    s_add_u32 s64, s64, 1
    s_cmp_eq_u64 vcc, 0
    s_cbranch_scc1 L_pdone_30
    s_sleep 4
    s_cmp_lt_u32 s64, 0x8000
    s_cbranch_scc1 L_poll_29
L_pdone_30:
    buffer_load_dwordx4 v[16:19], v5, s[16:19], s69 offen sc1
    s_add_u32 s69, s69, 32768
    buffer_load_dwordx4 v[20:23], v5, s[16:19], s69 offen sc1
    s_add_u32 s69, s69, 32768
    buffer_load_dwordx4 v[24:27], v5, s[16:19], s69 offen sc1
    s_add_u32 s69, s69, 32768
    buffer_load_dwordx4 v[28:31], v5, s[16:19], s69 offen sc1
    s_add_u32 s69, s69, 32768
    buffer_load_dwordx4 v[32:35], v5, s[16:19], s69 offen sc1
    s_add_u32 s69, s69, 32768
    buffer_load_dwordx4 v[36:39], v5, s[16:19], s69 offen sc1
    s_add_u32 s69, s69, 32768
    buffer_load_dwordx4 v[40:43], v5, s[16:19], s69 offen sc1
    s_add_u32 s69, s69, 32768
    buffer_load_dwordx4 v[44:47], v5, s[16:19], s69 offen sc1
    s_add_u32 s69, s69, 32768
    buffer_load_dwordx4 v[48:51], v5, s[16:19], s69 offen sc1
    s_add_u32 s69, s69, 32768
    buffer_load_dwordx4 v[52:55], v5, s[16:19], s69 offen sc1
    s_waitcnt vmcnt(9)
    ds_write_b128 v6, v[16:19] offset:0
    s_waitcnt vmcnt(8)
    ds_write_b128 v6, v[20:23] offset:1024
    s_waitcnt vmcnt(7)
    ds_write_b128 v6, v[24:27] offset:2048
    s_waitcnt vmcnt(6)
    ds_write_b128 v6, v[28:31] offset:3072
    s_waitcnt vmcnt(5)
    ds_write_b128 v6, v[32:35] offset:4096
    s_waitcnt vmcnt(4)
    ds_write_b128 v6, v[36:39] offset:5120
    s_waitcnt vmcnt(3)
    ds_write_b128 v6, v[40:43] offset:6144
    s_waitcnt vmcnt(2)
    ds_write_b128 v6, v[44:47] offset:7168
    s_waitcnt vmcnt(1)
    ds_write_b128 v6, v[48:51] offset:8192
    s_waitcnt vmcnt(0)
    ds_write_b128 v6, v[52:55] offset:9216
L_join:
    s_waitcnt lgkmcnt(0)
    s_barrier
    s_endpgm
L_aux:
    s_and_b32 s3, s2, 7
    s_lshl_b32 s3, s3, 3
    s_bfe_u32 s64, s2, 0x30003
    s_add_u32 s3, s3, s64
    s_sub_u32 s66, s60, 4
    v_lshlrev_b32 v8, 4, v0
    v_lshlrev_b32 v9, 2, v0
    v_add_u32 v3, 157696, v9
    v_mov_b32 v4, 0
    ds_write_b32 v3, v4
    v_mov_b32 v196, 157696
    v_mov_b32 v199, 1
    s_mul_i32 s77, s60, 4608
    v_lshrrev_b32 v1, 2, v0
    v_and_b32 v18, 3, v0
    v_mul_u32_u24 v12, 1280, v1
    v_lshl_add_u32 v12, v18, 4, v12
    s_lshl_b32 s67, s3, 5
    s_sub_u32 s67, s67, 4
    s_mul_i32 s67, s67, 1280
    s_lshl_b32 s73, s60, 6
    s_add_u32 s67, s67, s73
    v_add_u32 v13, s67, v12
    v_add_u32 v14, 20480, v13
    v_add_u32 v15, 40960, v13
    v_and_b32 v16, 31, v0
    s_lshl_b32 s73, s60, 5
    v_add_lshl_u32 v17, v16, s73, 3
    s_waitcnt lgkmcnt(0)
    s_load_dword s61, s[58:59], 0
    s_mov_b32 s20, s34
    s_and_b32 s21, s35, 0xffff
    s_mov_b32 s22, 2621440
    s_mov_b32 s23, 0x20000
    s_mov_b32 s24, s36
    s_and_b32 s25, s37, 0xffff
    s_mov_b32 s26, 2621440
    s_mov_b32 s27, 0x20000
    s_mov_b32 s28, s38
    s_and_b32 s29, s39, 0xffff
    s_mov_b32 s30, 5120
    s_mov_b32 s31, 0x20000
    buffer_load_dwordx2 v[10:11], v17, s[28:31], 0 offen
    s_add_u32 m0, s77, 0
    s_nop 0
    buffer_load_dwordx4 v13, s[20:23], 0 offen nt lds
    s_add_u32 m0, s77, 2304
    s_nop 0
    buffer_load_dwordx4 v13, s[24:27], 0 offen nt lds
    s_add_u32 m0, s77, 1024
    s_nop 0
    buffer_load_dwordx4 v14, s[20:23], 0 offen nt lds
    s_add_u32 m0, s77, 3328
    s_nop 0
    buffer_load_dwordx4 v14, s[24:27], 0 offen nt lds
    s_mov_b64 exec, 0xffff
    s_add_u32 m0, s77, 2048
    s_nop 0
    buffer_load_dwordx4 v15, s[20:23], 0 offen nt lds
    s_add_u32 m0, s77, 4352
    s_nop 0
    buffer_load_dwordx4 v15, s[24:27], 0 offen nt lds
    s_mov_b64 exec, -1
    s_lshl_b32 s79, s60, 12
    s_add_u32 s79, s79, 40960
    s_mov_b32 s8, s50
    s_and_b32 s9, s51, 0xffff
    s_mov_b32 s10, 1966080
    s_mov_b32 s11, 0x20000
    s_mov_b32 s12, s52
    s_and_b32 s13, s53, 0xffff
    s_mov_b32 s14, 1280
    s_mov_b32 s15, 0x20000
    s_mov_b32 s4, s32
    s_and_b32 s5, s33, 0xffff
    s_mov_b32 s6, 2621440
    s_mov_b32 s7, 0x20000
    s_lshl_b32 s79, s60, 12
    s_add_u32 s79, s79, 40960
    s_mul_i32 s64, s3, 15
    s_lshl_b32 s65, s60, 1
    s_add_u32 s65, s65, 0
    s_add_u32 s64, s64, s65
    s_mul_i32 s68, s64, 3277
    s_lshr_b32 s68, s68, 16
    s_mul_i32 s72, s68, 20
    s_sub_u32 s69, s64, s72
    s_cmp_ge_u32 s65, 15
    s_cselect_b32 s68, 100, s68
    s_mul_i32 s72, s68, 40960
    s_lshl_b32 s73, s69, 6
    s_add_u32 s72, s72, s73
    s_add_u32 s73, s72, 20480
    s_add_u32 m0, s79, 0
    s_nop 0
    buffer_load_dwordx4 v12, s[8:11], s72 offen nt lds
    s_add_u32 m0, s79, 1024
    s_nop 0
    buffer_load_dwordx4 v12, s[8:11], s73 offen nt lds
    s_mul_i32 s64, s3, 15
    s_lshl_b32 s65, s60, 1
    s_add_u32 s65, s65, 1
    s_add_u32 s64, s64, s65
    s_mul_i32 s70, s64, 3277
    s_lshr_b32 s70, s70, 16
    s_mul_i32 s72, s70, 20
    s_sub_u32 s71, s64, s72
    s_cmp_ge_u32 s65, 15
    s_cselect_b32 s70, 100, s70
    s_mul_i32 s72, s70, 40960
    s_lshl_b32 s73, s71, 6
    s_add_u32 s72, s72, s73
    s_add_u32 s73, s72, 20480
    s_add_u32 m0, s79, 2048
    s_nop 0
    buffer_load_dwordx4 v12, s[8:11], s72 offen nt lds
    s_add_u32 m0, s79, 3072
    s_nop 0
    buffer_load_dwordx4 v12, s[8:11], s73 offen nt lds
    s_lshl_b32 s76, s3, 3
    s_add_u32 s76, s76, s60
    s_mul_i32 s67, s76, 5120
    s_add_u32 s72, s67, 3840
    buffer_load_dwordx4 v[132:135], v8, s[12:15], 0 offen
    buffer_load_dword v136, v9, s[12:15], 0 offen offset:1024
    buffer_load_dwordx4 v[104:107], v8, s[4:7], s67 offen offset:0
    buffer_load_dword v108, v9, s[4:7], s67 offen offset:1024
    buffer_load_dwordx4 v[110:113], v8, s[4:7], s67 offen offset:1280
    buffer_load_dword v114, v9, s[4:7], s67 offen offset:2304
    buffer_load_dwordx4 v[116:119], v8, s[4:7], s67 offen offset:2560
    buffer_load_dword v120, v9, s[4:7], s67 offen offset:3584
    buffer_load_dwordx4 v[122:125], v8, s[4:7], s72 offen offset:0
    buffer_load_dword v126, v9, s[4:7], s72 offen offset:1024
    s_getpc_b64 s[72:73]
L_pc:
    s_sub_u32 s72, s72, L_pc - gated_mix__ssm_conv_h3__glu_gated_bilinear__prompt_kernel
    s_subb_u32 s73, s73, 0
    s_and_b32 s64, s3, 7
    s_mul_i32 s64, s64, (L_end - gated_mix__ssm_conv_h3__glu_gated_bilinear__prompt_kernel) >> 10
    s_cmp_lg_u32 s60, 7
    s_cselect_b32 s65, 0, ((L_end - gated_mix__ssm_conv_h3__glu_gated_bilinear__prompt_kernel) >> 10) - 1
    v_min_u32 v3, s65, v0
    v_add_lshl_u32 v3, v3, s64, 7
    global_load_dword v39, v3, s[72:73]
    s_mov_b32 s16, s58
    s_and_b32 s17, s59, 0xffff
    s_mov_b32 s18, 14680064
    s_mov_b32 s19, 0x20000
    v_lshrrev_b32 v25, 2, v0
    v_bfe_u32 v23, v25, 1, 2
    v_xor_b32 v23, v23, v18
    v_lshlrev_b32 v23, 4, v23
    v_lshl_add_u32 v23, v25, 6, v23
    v_add_u32 v23, s77, v23
    v_lshlrev_b32 v24, 12, v25
    v_lshl_add_u32 v24, v18, 4, v24
    v_lshrrev_b32 v25, 5, v0
    v_lshlrev_b32 v20, 10, v25
    v_bfe_u32 v22, v0, 2, 2
    v_lshl_add_u32 v20, v22, 6, v20
    v_bfe_u32 v22, v0, 4, 1
    v_lshl_add_u32 v20, v22, 5, v20
    v_lshl_add_u32 v20, v18, 3, v20
    v_add_u32 v20, s77, v20
    v_sub_u32 v25, 1, v25
    v_lshlrev_b32 v25, 1, v25
    v_bfe_u32 v22, v16, 1, 2
    v_xor_b32 v25, v25, v22
    v_lshlrev_b32 v25, 4, v25
    v_lshl_add_u32 v22, v16, 6, v25
    v_add_u32 v21, s77, v22
    v_xor_b32 v22, 16, v21
    s_sub_u32 s78, 63, s3
    s_lshl_b32 s78, s78, 6
    s_add_u32 s78, s78, 1048576
    s_lshl_b32 s67, s60, 17
    s_add_u32 s78, s78, s67
    v_lshrrev_b32 v38, 2, v0
    v_lshlrev_b32 v38, 6, v38
    v_lshl_add_u32 v38, v18, 3, v38
    v_add_u32 v38, s79, v38
    s_waitcnt lgkmcnt(0)
    s_barrier
    s_mul_i32 s61, s61, 1664525
    s_add_u32 s61, s61, 1013904223
    s_waitcnt vmcnt(15)
    ds_read_b64_tr_b16 v[40:41], v20 offset:0
    ds_read_b64_tr_b16 v[42:43], v20 offset:256
    ds_read_b64_tr_b16 v[44:45], v20 offset:512
    ds_read_b64_tr_b16 v[46:47], v20 offset:768
    ds_read_b64_tr_b16 v[48:49], v20 offset:1024
    ds_read_b64_tr_b16 v[50:51], v20 offset:2560
    ds_read_b64_tr_b16 v[52:53], v20 offset:2816
    ds_read_b64_tr_b16 v[54:55], v20 offset:3072
    ds_read_b64_tr_b16 v[56:57], v20 offset:3328
    v_alignbit_b32 v10, v10, v10, 16
    v_alignbit_b32 v11, v11, v11, 16
    s_waitcnt lgkmcnt(4)
    v_alignbit_b32 v58, v41, v40, 16
    v_alignbit_b32 v59, v42, v41, 16
    v_alignbit_b32 v60, v43, v42, 16
    v_alignbit_b32 v61, v44, v43, 16
    v_alignbit_b32 v62, v45, v44, 16
    v_alignbit_b32 v63, v46, v45, 16
    v_alignbit_b32 v64, v47, v46, 16
    v_alignbit_b32 v65, v48, v47, 16
    v_alignbit_b32 v66, v49, v48, 16
    v_dot2_f32_bf16 v68, v58, v11, 0
    v_dot2_f32_bf16 v69, v41, v11, 0
    v_dot2_f32_bf16 v70, v59, v11, 0
    v_dot2_f32_bf16 v71, v42, v11, 0
    v_dot2_f32_bf16 v72, v60, v11, 0
    v_dot2_f32_bf16 v73, v43, v11, 0
    v_dot2_f32_bf16 v74, v61, v11, 0
    v_dot2_f32_bf16 v75, v44, v11, 0
    v_dot2_f32_bf16 v76, v62, v11, 0
    v_dot2_f32_bf16 v77, v45, v11, 0
    v_dot2_f32_bf16 v78, v63, v11, 0
    v_dot2_f32_bf16 v79, v46, v11, 0
    v_dot2_f32_bf16 v80, v64, v11, 0
    v_dot2_f32_bf16 v81, v47, v11, 0
    v_dot2_f32_bf16 v82, v65, v11, 0
    v_dot2_f32_bf16 v83, v48, v11, 0
    v_dot2_f32_bf16 v68, v59, v10, v68
    v_dot2_f32_bf16 v69, v42, v10, v69
    v_dot2_f32_bf16 v70, v60, v10, v70
    v_dot2_f32_bf16 v71, v43, v10, v71
    v_dot2_f32_bf16 v72, v61, v10, v72
    v_dot2_f32_bf16 v73, v44, v10, v73
    v_dot2_f32_bf16 v74, v62, v10, v74
    v_dot2_f32_bf16 v75, v45, v10, v75
    v_dot2_f32_bf16 v76, v63, v10, v76
    v_dot2_f32_bf16 v77, v46, v10, v77
    v_dot2_f32_bf16 v78, v64, v10, v78
    v_dot2_f32_bf16 v79, v47, v10, v79
    v_dot2_f32_bf16 v80, v65, v10, v80
    v_dot2_f32_bf16 v81, v48, v10, v81
    v_dot2_f32_bf16 v82, v66, v10, v82
    v_dot2_f32_bf16 v83, v49, v10, v83
    s_waitcnt lgkmcnt(0)
    v_lshlrev_b32 v40, 16, v50
    v_and_b32 v58, 0xffff0000, v50
    v_lshlrev_b32 v41, 16, v51
    v_and_b32 v59, 0xffff0000, v51
    v_lshlrev_b32 v42, 16, v52
    v_and_b32 v60, 0xffff0000, v52
    v_lshlrev_b32 v43, 16, v53
    v_and_b32 v61, 0xffff0000, v53
    v_lshlrev_b32 v44, 16, v54
    v_and_b32 v62, 0xffff0000, v54
    v_lshlrev_b32 v45, 16, v55
    v_and_b32 v63, 0xffff0000, v55
    v_lshlrev_b32 v46, 16, v56
    v_and_b32 v64, 0xffff0000, v56
    v_lshlrev_b32 v47, 16, v57
    v_and_b32 v65, 0xffff0000, v57
    v_mul_f32 v68, v68, v40
    v_mul_f32 v69, v69, v58
    v_mul_f32 v70, v70, v41
    v_mul_f32 v71, v71, v59
    v_mul_f32 v72, v72, v42
    v_mul_f32 v73, v73, v60
    v_mul_f32 v74, v74, v43
    v_mul_f32 v75, v75, v61
    v_mul_f32 v76, v76, v44
    v_mul_f32 v77, v77, v62
    v_mul_f32 v78, v78, v45
    v_mul_f32 v79, v79, v63
    v_mul_f32 v80, v80, v46
    v_mul_f32 v81, v81, v64
    v_mul_f32 v82, v82, v47
    v_mul_f32 v83, v83, v65
    v_cvt_pk_bf16_f32 v40, v83, v82
    v_cvt_pk_bf16_f32 v41, v81, v80
    v_cvt_pk_bf16_f32 v42, v79, v78
    v_cvt_pk_bf16_f32 v43, v77, v76
    v_cvt_pk_bf16_f32 v44, v75, v74
    v_cvt_pk_bf16_f32 v45, v73, v72
    v_cvt_pk_bf16_f32 v46, v71, v70
    v_cvt_pk_bf16_f32 v47, v69, v68
    ds_write_b128 v21, v[40:43]
    ds_write_b128 v22, v[44:47]
    s_waitcnt lgkmcnt(0)
    ds_read_b128 v[48:51], v23
    ds_read_b128 v[52:55], v23 offset:1024
    s_add_u32 s67, s78, 65536
    s_waitcnt lgkmcnt(1)
    buffer_store_dwordx4 v[48:51], v24, s[16:19], s78 offen sc1
    s_waitcnt lgkmcnt(0)
    buffer_store_dwordx4 v[52:55], v24, s[16:19], s67 offen sc1
    s_waitcnt vmcnt(13)
    ds_read_b64_tr_b16 v[148:149], v38 offset:0
    ds_read_b64_tr_b16 v[150:151], v38 offset:1024
    ds_read_b64_tr_b16 v[152:153], v38 offset:32
    ds_read_b64_tr_b16 v[154:155], v38 offset:1056
    ds_read_b64_tr_b16 v[156:157], v38 offset:2048
    ds_read_b64_tr_b16 v[158:159], v38 offset:3072
    ds_read_b64_tr_b16 v[160:161], v38 offset:2080
    ds_read_b64_tr_b16 v[162:163], v38 offset:3104
    s_waitcnt vmcnt(0)
    s_mov_b64 exec, 1
    ds_add_rtn_u32 v39, v196, v199 offset:8
    s_mov_b64 exec, -1
    s_waitcnt lgkmcnt(0)
    v_readfirstlane_b32 s67, v39

    s_lshr_b32 s72, s3, 3
    s_lshl_b32 s72, s72, 7
    s_and_b32 s73, s3, 7
    s_lshl_b32 s73, s73, 2
    s_add_u32 s72, s72, s73
    s_add_u32 s72, s72, 7168
    s_cmp_lg_u32 s67, 7
    s_cbranch_scc1 L_ax_nf1
    v_mov_b32 v1, s61
    v_mov_b32 v39, 0
    s_mov_b64 exec, 1
    buffer_store_dword v1, v39, s[16:19], s72 offen sc1
    s_mov_b64 exec, -1
L_ax_nf1:
    s_lshl_b32 s64, s69, 1
    s_add_u32 s64, s64, 0
    s_mul_i32 s65, s64, 13108
    s_lshr_b32 s65, s65, 16
    s_mul_i32 s72, s65, 5
    s_sub_u32 s64, s64, s72
    s_mul_i32 s65, s65, 48
    s_add_u32 s65, s65, s68
    s_mul_i32 s65, s65, 5
    s_add_u32 s65, s65, s64
    s_lshl_b32 s65, s65, 10
    s_add_u32 s65, s65, 12582912
    s_cmp_ge_u32 s68, 48
    s_cselect_b32 s65, 14680064, s65
    buffer_store_dwordx4 v[148:151], v8, s[16:19], s65 offen sc1
    s_lshl_b32 s64, s69, 1
    s_add_u32 s64, s64, 1
    s_mul_i32 s65, s64, 13108
    s_lshr_b32 s65, s65, 16
    s_mul_i32 s72, s65, 5
    s_sub_u32 s64, s64, s72
    s_mul_i32 s65, s65, 48
    s_add_u32 s65, s65, s68
    s_mul_i32 s65, s65, 5
    s_add_u32 s65, s65, s64
    s_lshl_b32 s65, s65, 10
    s_add_u32 s65, s65, 12582912
    s_cmp_ge_u32 s68, 48
    s_cselect_b32 s65, 14680064, s65
    buffer_store_dwordx4 v[152:155], v8, s[16:19], s65 offen sc1
    s_lshl_b32 s64, s71, 1
    s_add_u32 s64, s64, 0
    s_mul_i32 s65, s64, 13108
    s_lshr_b32 s65, s65, 16
    s_mul_i32 s72, s65, 5
    s_sub_u32 s64, s64, s72
    s_mul_i32 s65, s65, 48
    s_add_u32 s65, s65, s70
    s_mul_i32 s65, s65, 5
    s_add_u32 s65, s65, s64
    s_lshl_b32 s65, s65, 10
    s_add_u32 s65, s65, 12582912
    s_cmp_ge_u32 s70, 48
    s_cselect_b32 s65, 14680064, s65
    buffer_store_dwordx4 v[156:159], v8, s[16:19], s65 offen sc1
    s_lshl_b32 s64, s71, 1
    s_add_u32 s64, s64, 1
    s_mul_i32 s65, s64, 13108
    s_lshr_b32 s65, s65, 16
    s_mul_i32 s72, s65, 5
    s_sub_u32 s64, s64, s72
    s_mul_i32 s65, s65, 48
    s_add_u32 s65, s65, s70
    s_mul_i32 s65, s65, 5
    s_add_u32 s65, s65, s64
    s_lshl_b32 s65, s65, 10
    s_add_u32 s65, s65, 12582912
    s_cmp_ge_u32 s70, 48
    s_cselect_b32 s65, 14680064, s65
    buffer_store_dwordx4 v[160:163], v8, s[16:19], s65 offen sc1
    v_dot2_f32_bf16 v140, v104, v132, 0
    v_dot2_f32_bf16 v141, v110, v132, 0
    v_dot2_f32_bf16 v142, v116, v132, 0
    v_dot2_f32_bf16 v143, v122, v132, 0
    v_dot2_f32_bf16 v140, v105, v133, v140
    v_dot2_f32_bf16 v141, v111, v133, v141
    v_dot2_f32_bf16 v142, v117, v133, v142
    v_dot2_f32_bf16 v143, v123, v133, v143
    v_dot2_f32_bf16 v140, v106, v134, v140
    v_dot2_f32_bf16 v141, v112, v134, v141
    v_dot2_f32_bf16 v142, v118, v134, v142
    v_dot2_f32_bf16 v143, v124, v134, v143
    v_dot2_f32_bf16 v140, v107, v135, v140
    v_dot2_f32_bf16 v141, v113, v135, v141
    v_dot2_f32_bf16 v142, v119, v135, v142
    v_dot2_f32_bf16 v143, v125, v135, v143
    v_dot2_f32_bf16 v140, v108, v136, v140
    v_dot2_f32_bf16 v141, v114, v136, v141
    v_dot2_f32_bf16 v142, v120, v136, v142
    v_dot2_f32_bf16 v143, v126, v136, v143
    s_nop 0
    v_add_f32_dpp v140, v140, v140 row_shr:1 row_mask:0xf bank_mask:0xf bound_ctrl:0
    v_add_f32_dpp v141, v141, v141 row_shr:1 row_mask:0xf bank_mask:0xf bound_ctrl:0
    v_add_f32_dpp v142, v142, v142 row_shr:1 row_mask:0xf bank_mask:0xf bound_ctrl:0
    v_add_f32_dpp v143, v143, v143 row_shr:1 row_mask:0xf bank_mask:0xf bound_ctrl:0
    v_add_f32_dpp v140, v140, v140 row_shr:2 row_mask:0xf bank_mask:0xf bound_ctrl:0
    v_add_f32_dpp v141, v141, v141 row_shr:2 row_mask:0xf bank_mask:0xf bound_ctrl:0
    v_add_f32_dpp v142, v142, v142 row_shr:2 row_mask:0xf bank_mask:0xf bound_ctrl:0
    v_add_f32_dpp v143, v143, v143 row_shr:2 row_mask:0xf bank_mask:0xf bound_ctrl:0
    v_add_f32_dpp v140, v140, v140 row_shr:4 row_mask:0xf bank_mask:0xf bound_ctrl:0
    v_add_f32_dpp v141, v141, v141 row_shr:4 row_mask:0xf bank_mask:0xf bound_ctrl:0
    v_add_f32_dpp v142, v142, v142 row_shr:4 row_mask:0xf bank_mask:0xf bound_ctrl:0
    v_add_f32_dpp v143, v143, v143 row_shr:4 row_mask:0xf bank_mask:0xf bound_ctrl:0
    v_add_f32_dpp v140, v140, v140 row_shr:8 row_mask:0xf bank_mask:0xf bound_ctrl:0
    v_add_f32_dpp v141, v141, v141 row_shr:8 row_mask:0xf bank_mask:0xf bound_ctrl:0
    v_add_f32_dpp v142, v142, v142 row_shr:8 row_mask:0xf bank_mask:0xf bound_ctrl:0
    v_add_f32_dpp v143, v143, v143 row_shr:8 row_mask:0xf bank_mask:0xf bound_ctrl:0
    v_add_f32_dpp v140, v140, v140 row_bcast:15 row_mask:0xa bank_mask:0xf
    v_add_f32_dpp v141, v141, v141 row_bcast:15 row_mask:0xa bank_mask:0xf
    v_add_f32_dpp v142, v142, v142 row_bcast:15 row_mask:0xa bank_mask:0xf
    v_add_f32_dpp v143, v143, v143 row_bcast:15 row_mask:0xa bank_mask:0xf
    v_add_f32_dpp v140, v140, v140 row_bcast:31 row_mask:0xc bank_mask:0xf
    v_add_f32_dpp v141, v141, v141 row_bcast:31 row_mask:0xc bank_mask:0xf
    v_add_f32_dpp v142, v142, v142 row_bcast:31 row_mask:0xc bank_mask:0xf
    v_add_f32_dpp v143, v143, v143 row_bcast:31 row_mask:0xc bank_mask:0xf
    v_cvt_pk_bf16_f32 v140, v140, v140
    v_cvt_pk_bf16_f32 v141, v141, v141
    v_cvt_pk_bf16_f32 v142, v142, v142
    v_cvt_pk_bf16_f32 v143, v143, v143
    v_and_b32 v140, 0xffff0000, v140
    v_and_b32 v141, 0xffff0000, v141
    v_and_b32 v142, 0xffff0000, v142
    v_and_b32 v143, 0xffff0000, v143
    v_mul_f32 v140, 0xbfb8aa3b, v140
    v_mul_f32 v141, 0xbfb8aa3b, v141
    v_mul_f32 v142, 0xbfb8aa3b, v142
    v_mul_f32 v143, 0xbfb8aa3b, v143
    v_exp_f32 v140, v140
    v_exp_f32 v141, v141
    v_exp_f32 v142, v142
    v_exp_f32 v143, v143
    v_add_f32 v140, 1.0, v140
    v_add_f32 v141, 1.0, v141
    v_add_f32 v142, 1.0, v142
    v_add_f32 v143, 1.0, v143
    v_rcp_f32 v140, v140
    v_rcp_f32 v141, v141
    v_rcp_f32 v142, v142
    v_rcp_f32 v143, v143
    v_cvt_pk_bf16_f32 v140, v140, v140
    v_cvt_pk_bf16_f32 v141, v141, v141
    v_cvt_pk_bf16_f32 v142, v142, v142
    v_cvt_pk_bf16_f32 v143, v143, v143
    v_and_b32 v140, 0xffff0000, v140
    v_and_b32 v141, 0xffff0000, v141
    v_and_b32 v142, 0xffff0000, v142
    v_and_b32 v143, 0xffff0000, v143
    s_lshr_b32 s67, s76, 1
    s_lshl_b32 s67, s67, 7
    s_and_b32 s72, s76, 1
    s_lshl_b32 s72, s72, 4
    s_add_u32 s67, s67, s72
    s_add_u32 s67, s67, 262144
    v_mov_b32 v1, 0
    s_mov_b32 exec_lo, 0
    s_mov_b32 exec_hi, 0x80000000
    buffer_store_dwordx4 v[140:143], v1, s[16:19], s67 offen sc1
    s_mov_b64 exec, -1
    s_waitcnt vmcnt(0)
    s_mov_b64 exec, 1
    ds_add_rtn_u32 v39, v196, v199 offset:24
    s_mov_b64 exec, -1
    s_waitcnt lgkmcnt(0)
    v_readfirstlane_b32 s67, v39

    s_lshr_b32 s72, s3, 3
    s_lshl_b32 s72, s72, 7
    s_and_b32 s73, s3, 7
    s_lshl_b32 s73, s73, 2
    s_add_u32 s72, s72, s73
    s_add_u32 s72, s72, 8192
    s_cmp_lg_u32 s67, 7
    s_cbranch_scc1 L_ax_nf2
    v_mov_b32 v1, s61
    v_mov_b32 v39, 0
    s_mov_b64 exec, 1
    buffer_store_dword v1, v39, s[16:19], s72 offen sc1
    s_mov_b64 exec, -1
L_ax_nf2:
    s_cmp_lt_u32 s60, 4
    s_cbranch_scc1 L_ax_c
    s_mov_b32 s56, 0
L_lw_31:
    ds_read_b32 v197, v196 offset:24
    s_add_u32 s56, s56, 1
    s_waitcnt lgkmcnt(0)
    v_readfirstlane_b32 s57, v197
    s_cmp_ge_u32 s56, 0x100000
    s_cselect_b32 s57, 8, s57
    s_cmp_ge_u32 s57, 8
    s_cbranch_scc1 L_lwd_32
    s_sleep 2
    s_branch L_lw_31
L_lwd_32:
    s_lshl_b32 s67, s3, 2
    s_add_u32 s67, s67, s66
    s_add_u32 s67, s67, 384
    s_mov_b32 s68, 49152
    s_cmp_eq_u32 s66, 1
    s_cselect_b32 s68, 70400, s68
    s_cmp_eq_u32 s66, 2
    s_cselect_b32 s68, 98304, s68
    s_cmp_eq_u32 s66, 3
    s_cselect_b32 s68, 0, s68
    s_mov_b32 s20, s40
    s_and_b32 s21, s41, 0xffff
    s_mov_b32 s22, 2621440
    s_mov_b32 s23, 0x20000
    s_mov_b32 s24, s42
    s_and_b32 s25, s43, 0xffff
    s_mov_b32 s26, 1280
    s_mov_b32 s27, 0x20000
    s_lshl_b32 s69, s67, 12
    s_add_u32 s70, s68, 16640
    v_lshlrev_b32 v10, 4, v0
    s_add_u32 s71, s69, 0
    s_add_u32 m0, s68, 32
    s_nop 0
    buffer_load_dwordx4 v10, s[20:23], s71 offen offset:0 nt lds
    buffer_load_dwordx4 v10, s[20:23], s71 offen offset:1024 nt lds
    buffer_load_dwordx4 v10, s[20:23], s71 offen offset:2048 nt lds
    buffer_load_dwordx4 v10, s[20:23], s71 offen offset:3072 nt lds
    s_add_u32 s71, s69, 4
    s_add_u32 m0, s68, 8352
    s_nop 0
    buffer_load_dwordx4 v10, s[20:23], s71 offen offset:0 nt lds
    buffer_load_dwordx4 v10, s[20:23], s71 offen offset:1024 nt lds
    buffer_load_dwordx4 v10, s[20:23], s71 offen offset:2048 nt lds
    buffer_load_dwordx4 v10, s[20:23], s71 offen offset:3072 nt lds
    v_lshrrev_b32 v1, 4, v0
    v_and_b32 v2, 15, v0
    v_add3_u32 v3, v1, v2, -16
    v_lshlrev_b32 v4, 1, v3
    v_add_u32 v4, s69, v4
    v_cmp_gt_i32 vcc, 0, v3
    s_lshl_b32 s71, s67, 1
    v_mov_b32 v7, s71
    v_cndmask_b32 v4, v4, -1, vcc
    buffer_load_ushort v5, v4, s[20:23], 0 offen
    buffer_load_ushort v7, v7, s[24:27], 0 offen
    v_mul_u32_u24 v8, 4160, v1
    v_add_u32 v8, s68, v8
    v_lshl_add_u32 v9, v2, 1, v8
    v_add_u32 v11, s68, v10
    v_mov_b32 v12, 0
    v_mov_b32 v13, 0
    v_lshl_add_u32 v14, v0, 3, s70
    ds_write_b64 v14, v[12:13] offset:4096
    v_add_u32 v3, 1, v2
    v_and_b32 v4, 3, v3
    v_sub_u32 v3, v3, v4
    v_lshl_add_u32 v3, v1, 3, v3
    v_mul_u32_u24 v4, 4160, v4
    v_lshl_add_u32 v20, v3, 1, v4
    v_add_u32 v20, s68, v20
    v_lshlrev_b32 v3, 4, v1
    v_lshlrev_b32 v4, 5, v2
    v_sub_u32 v3, v3, v4
    v_add_u32 v3, 480, v3
    v_add_u32 v21, s70, v3
    v_mov_b32 v32, 0
    v_mov_b32 v33, 0
    v_mov_b32 v34, 0
    v_mov_b32 v35, 0
    v_mov_b32 v36, 0
    v_mov_b32 v37, 0
    v_mov_b32 v38, 0
    v_mov_b32 v39, 0
    v_mov_b32 v40, 0
    v_mov_b32 v41, 0
    v_mov_b32 v42, 0
    v_mov_b32 v43, 0
    v_mov_b32 v44, 0
    v_mov_b32 v45, 0
    v_mov_b32 v46, 0
    v_mov_b32 v47, 0
    v_mov_b32 v48, 0
    v_mov_b32 v49, 0
    v_mov_b32 v50, 0
    v_mov_b32 v51, 0
    v_mov_b32 v52, 0
    v_mov_b32 v53, 0
    v_mov_b32 v54, 0
    v_mov_b32 v55, 0
    v_mov_b32 v56, 0
    v_mov_b32 v57, 0
    v_mov_b32 v58, 0
    v_mov_b32 v59, 0
    v_mov_b32 v60, 0
    v_mov_b32 v61, 0
    v_mov_b32 v62, 0
    v_mov_b32 v63, 0
    s_waitcnt vmcnt(0)
    ds_read_b128 v[64:67], v11 offset:32
    ds_read_b128 v[68:71], v11 offset:8352
    ds_read_b64 v[74:75], v11 offset:48
    ds_read_b128 v[80:83], v11 offset:1056
    ds_read_b128 v[84:87], v11 offset:9376
    ds_read_b64 v[90:91], v11 offset:1072
    ds_read_b128 v[96:99], v11 offset:2080
    ds_read_b128 v[100:103], v11 offset:10400
    ds_read_b64 v[106:107], v11 offset:2096
    ds_read_b128 v[112:115], v11 offset:3104
    ds_read_b128 v[116:119], v11 offset:11424
    ds_read_b64 v[122:123], v11 offset:3120
    ds_write_b16 v9, v5
    v_lshlrev_b32 v7, 16, v7
    s_waitcnt lgkmcnt(10)
    v_alignbit_b32 v76, v68, v64, 16
    v_alignbit_b32 v77, v69, v65, 16
    v_alignbit_b32 v78, v70, v66, 16
    v_alignbit_b32 v79, v71, v67, 16
    v_alignbit_b32 v68, v66, v68, 16
    v_alignbit_b32 v69, v67, v69, 16
    v_alignbit_b32 v70, v74, v70, 16
    v_alignbit_b32 v71, v75, v71, 16
    ds_write_b128 v11, v[76:79] offset:4192
    ds_write_b128 v11, v[68:71] offset:12512
    s_waitcnt lgkmcnt(9)
    v_alignbit_b32 v92, v84, v80, 16
    v_alignbit_b32 v93, v85, v81, 16
    v_alignbit_b32 v94, v86, v82, 16
    v_alignbit_b32 v95, v87, v83, 16
    v_alignbit_b32 v84, v82, v84, 16
    v_alignbit_b32 v85, v83, v85, 16
    v_alignbit_b32 v86, v90, v86, 16
    v_alignbit_b32 v87, v91, v87, 16
    ds_write_b128 v11, v[92:95] offset:5216
    ds_write_b128 v11, v[84:87] offset:13536
    s_waitcnt lgkmcnt(8)
    v_alignbit_b32 v108, v100, v96, 16
    v_alignbit_b32 v109, v101, v97, 16
    v_alignbit_b32 v110, v102, v98, 16
    v_alignbit_b32 v111, v103, v99, 16
    v_alignbit_b32 v100, v98, v100, 16
    v_alignbit_b32 v101, v99, v101, 16
    v_alignbit_b32 v102, v106, v102, 16
    v_alignbit_b32 v103, v107, v103, 16
    ds_write_b128 v11, v[108:111] offset:6240
    ds_write_b128 v11, v[100:103] offset:14560
    s_waitcnt lgkmcnt(7)
    v_alignbit_b32 v124, v116, v112, 16
    v_alignbit_b32 v125, v117, v113, 16
    v_alignbit_b32 v126, v118, v114, 16
    v_alignbit_b32 v127, v119, v115, 16
    v_alignbit_b32 v116, v114, v116, 16
    v_alignbit_b32 v117, v115, v117, 16
    v_alignbit_b32 v118, v122, v118, 16
    v_alignbit_b32 v119, v123, v119, 16
    ds_write_b128 v11, v[124:127] offset:7264
    ds_write_b128 v11, v[116:119] offset:15584
    s_mov_b32 s56, 0
L_lw_33:
    ds_read_b32 v197, v196 offset:12
    s_add_u32 s56, s56, 1
    s_waitcnt lgkmcnt(0)
    v_readfirstlane_b32 s57, v197
    s_cmp_ge_u32 s56, 0x100000
    s_cselect_b32 s57, 1, s57
    s_cmp_ge_u32 s57, 1
    s_cbranch_scc1 L_lwd_34
    s_sleep 2
    s_branch L_lw_33
L_lwd_34:
    s_add_u32 s71, s69, 1048576
    s_mov_b32 m0, s70
    s_nop 0
    buffer_load_dwordx4 v10, s[16:19], s71 offen offset:0 sc1 lds
    buffer_load_dwordx4 v10, s[16:19], s71 offen offset:1024 sc1 lds
    buffer_load_dwordx4 v10, s[16:19], s71 offen offset:2048 sc1 lds
    buffer_load_dwordx4 v10, s[16:19], s71 offen offset:3072 sc1 lds
    s_mov_b32 s74, 4
    s_mov_b32 s75, 0
    s_branch L_conv_main
L_ax_c:
    s_and_b32 s64, s3, 7
    s_lshl_b32 s64, s64, 2
    s_add_u32 s64, s64, s60
    s_lshr_b32 s65, s3, 3
    s_cmp_lg_u32 s60, 0
    s_cbranch_scc1 L_ax_c1
    v_lshlrev_b32 v15, 7, v0
    v_add_u32 v16, 12288, v15
    v_add_u32 v17, 20480, v15
    v_add_u32 v18, 28672, v15
    v_add_u32 v19, 36864, v15
    v_add_u32 v15, 4096, v15
    s_lshl_b32 s73, s65, 7
    s_add_u32 s73, s73, 1024
    s_and_b32 s72, s3, 7
    s_cmp_eq_u32 s72, 0
    s_cbranch_scc1 L_agg
    v_mov_b32 v15, s73
    v_add_u32 v16, 1024, v15
    v_min_u32 v15, 63, v0
    v_and_b32 v197, 1, v15
    v_lshrrev_b32 v15, 1, v15
    v_lshlrev_b32 v15, 7, v15
    v_lshl_add_u32 v15, v197, 4, v15
    v_add_u32 v15, 4096, v15
    s_mov_b32 s72, 0
L_poll_35:
    buffer_load_dwordx4 v[20:23], v15, s[16:19], 0 offen sc1
    s_waitcnt vmcnt(0)
    v_xor_b32 v20, s61, v20
    v_xor_b32 v21, s61, v21
    v_xor_b32 v22, s61, v22
    v_xor_b32 v23, s61, v23
    v_or3_b32 v20, v20, v21, v22
    v_or_b32 v20, v20, v23
    v_cmp_ne_u32 vcc, 0, v20
    s_add_u32 s72, s72, 1
    s_cmp_eq_u64 vcc, 0
    s_cbranch_scc1 L_pdone_36
    s_sleep 12
    s_cmp_lt_u32 s72, 0x8000
    s_cbranch_scc1 L_poll_35
L_pdone_36:
    s_mov_b64 exec, 1
    ds_add_u32 v196, v199 offset:12
    s_mov_b64 exec, -1
    s_mov_b32 s72, 0
L_poll_37:
    buffer_load_dword v20, v16, s[16:19], 0 offen sc1
    s_waitcnt vmcnt(0)
    v_xor_b32 v20, s61, v20
    v_cmp_ne_u32 vcc, 0, v20
    s_add_u32 s72, s72, 1
    s_cmp_eq_u64 vcc, 0
    s_cbranch_scc1 L_pdone_38
    s_sleep 12
    s_cmp_lt_u32 s72, 0x8000
    s_cbranch_scc1 L_poll_37
L_pdone_38:
    s_mov_b64 exec, 1
    ds_add_u32 v196, v199 offset:20
    s_mov_b64 exec, -1
    s_branch L_ax_c1
L_agg:
    v_min_u32 v15, 63, v0
    v_and_b32 v197, 1, v15
    v_lshrrev_b32 v15, 1, v15
    v_lshlrev_b32 v15, 7, v15
    v_lshl_add_u32 v15, v197, 4, v15
    v_add_u32 v15, 4096, v15
    v_min_u32 v16, 15, v0
    v_and_b32 v197, 1, v16
    v_lshrrev_b32 v16, 1, v16
    v_lshlrev_b32 v16, 7, v16
    v_lshl_add_u32 v16, v197, 4, v16
    v_add_u32 v16, 8192, v16
    s_mov_b32 s72, 0
L_poll_39:
    buffer_load_dwordx4 v[20:23], v15, s[16:19], 0 offen sc1
    s_waitcnt vmcnt(0)
    v_xor_b32 v20, s61, v20
    v_xor_b32 v21, s61, v21
    v_xor_b32 v22, s61, v22
    v_xor_b32 v23, s61, v23
    v_or3_b32 v20, v20, v21, v22
    v_or_b32 v20, v20, v23
    v_cmp_ne_u32 vcc, 0, v20
    s_add_u32 s72, s72, 1
    s_cmp_eq_u64 vcc, 0
    s_cbranch_scc1 L_pdone_40
    s_sleep 4
    s_cmp_lt_u32 s72, 0x8000
    s_cbranch_scc1 L_poll_39
L_pdone_40:
    v_mov_b32 v1, s61
    v_mov_b32 v2, 0
    s_mov_b64 exec, 1
    buffer_store_dword v1, v2, s[16:19], s73 offen sc1
    s_mov_b64 exec, -1
    s_mov_b64 exec, 1
    ds_add_u32 v196, v199 offset:12
    s_mov_b64 exec, -1
    s_mov_b32 s72, 0
L_poll_41:
    buffer_load_dwordx4 v[20:23], v16, s[16:19], 0 offen sc1
    s_waitcnt vmcnt(0)
    v_xor_b32 v20, s61, v20
    v_xor_b32 v21, s61, v21
    v_xor_b32 v22, s61, v22
    v_xor_b32 v23, s61, v23
    v_or3_b32 v20, v20, v21, v22
    v_or_b32 v20, v20, v23
    v_cmp_ne_u32 vcc, 0, v20
    s_add_u32 s72, s72, 1
    s_cmp_eq_u64 vcc, 0
    s_cbranch_scc1 L_pdone_42
    s_sleep 4
    s_cmp_lt_u32 s72, 0x8000
    s_cbranch_scc1 L_poll_41
L_pdone_42:
    s_add_u32 s73, s73, 1024
    v_mov_b32 v1, s61
    v_mov_b32 v2, 0
    s_mov_b64 exec, 1
    buffer_store_dword v1, v2, s[16:19], s73 offen sc1
    s_mov_b64 exec, -1
    s_mov_b64 exec, 1
    ds_add_u32 v196, v199 offset:20
    s_mov_b64 exec, -1
L_ax_c1:
    s_mov_b32 s56, 0
L_lw_43:
    ds_read_b32 v197, v196 offset:20
    s_add_u32 s56, s56, 1
    s_waitcnt lgkmcnt(0)
    v_readfirstlane_b32 s57, v197
    s_cmp_ge_u32 s56, 0x100000
    s_cselect_b32 s57, 1, s57
    s_cmp_ge_u32 s57, 1
    s_cbranch_scc1 L_lwd_44
    s_sleep 2
    s_branch L_lw_43
L_lwd_44:
    s_mov_b32 s20, s54
    s_and_b32 s21, s55, 0xffff
    s_mov_b32 s22, 2621440
    s_mov_b32 s23, 0x20000
    s_mov_b32 s4, s32
    s_and_b32 s5, s33, 0xffff
    s_mov_b32 s6, 2621440
    s_mov_b32 s7, 0x20000
    s_and_b32 s69, s2, 1
    s_lshl_b32 s69, s69, 4
    s_and_b32 s66, s2, 2
    s_lshl_b32 s66, s66, 2
    s_add_u32 s69, s69, s66
    s_bfe_u32 s66, s2, 0x30003
    s_add_u32 s69, s69, s66
    s_and_b32 s70, s2, 4
    s_lshr_b32 s78, s2, 6
    s_add_u32 s70, s70, s78
    s_lshl_b32 s78, s78, 1
    s_add_u32 s66, s66, s78
    s_mov_b32 s76, 0
    s_mov_b32 s78, 1
    s_mul_i32 s74, s69, 196608
    s_mul_i32 s66, s60, 49152
    s_add_u32 s74, s74, s66
    s_add_u32 s74, s74, 6291456
    s_mul_i32 s75, s70, 245760
    s_mul_i32 s66, s60, 61440
    s_add_u32 s75, s75, s66
    s_add_u32 s75, s75, 12582912
    s_mov_b32 s77, s76

    v_and_b32 v1, 15, v0
    v_lshrrev_b32 v2, 4, v0
    s_lshl_b32 s66, s69, 6
    s_lshl_b32 s67, s60, 4
    s_add_u32 s66, s66, s67
    v_add_u32 v8, s66, v1
    v_mul_u32_u24 v3, 1280, v8
    v_lshl_add_u32 v3, v2, 3, v3
    s_mul_i32 s67, s70, 160
    v_add_u32 v3, s67, v3
    v_lshrrev_b32 v9, 3, v8
    v_lshlrev_b32 v9, 7, v9
    v_and_b32 v8, 7, v8
    v_lshl_add_u32 v9, v8, 2, v9
    v_add_u32 v6, 262144, v9
    v_min_u32 v1, 5, v0
    v_lshlrev_b32 v1, 1, v1
    s_lshr_b32 s66, s69, 1
    s_mul_i32 s66, s66, 12
    s_mul_i32 s67, s60, 3
    s_add_u32 s66, s66, s67
    s_lshl_b32 s66, s66, 2
    s_and_b32 s67, s69, 1
    s_add_u32 s66, s66, s67
    v_add_lshl_u32 v1, v1, s66, 7
    v_add_u32 v7, 131072, v1
    v_lshlrev_b32 v4, 4, v0
    v_add_u32 v5, 4096, v4
    v_mov_b32 v173, 157696
    v_mov_b32 v175, 1
    s_mov_b64 exec, 1
    ds_add_u32 v173, v175 offset:4
    s_mov_b64 exec, -1
    s_mov_b32 s73, 14680064
    s_branch L_g2
L_end:
    s_endpgm
.section .rodata,"a"
.p2align 6
.amdhsa_kernel gated_mix__ssm_conv_h3__glu_gated_bilinear__prompt_kernel
  .amdhsa_next_free_vgpr 256
  .amdhsa_next_free_sgpr 102
  .amdhsa_accum_offset 256
  .amdhsa_group_segment_fixed_size 0
  .amdhsa_kernarg_size 112
  .amdhsa_user_sgpr_count 2
  .amdhsa_user_sgpr_kernarg_segment_ptr 1
  .amdhsa_system_sgpr_workgroup_id_x 1
.end_amdhsa_kernel
```
